```python
import torch

def _softmax(x, axis=-1):
    return torch.softmax(x, dim=axis)

def _gelu(x):
    return torch.nn.functional.gelu(x, approximate='tanh')

def _silu(x):
    return torch.nn.functional.silu(x)

def _sigmoid(x):
    return torch.sigmoid(x)

def _layernorm(x, axis=-1, eps=1e-05):
    m = x.mean(dim=axis, keepdim=True)
    v = x.var(dim=axis, keepdim=True, unbiased=False)
    return (x - m) / torch.sqrt(v + eps)

def _scatter_add(tgt, idx, src, axis=0):
    return tgt.clone().index_add_(axis, idx, src)

def _segment_sum(src, seg, n):
    out = torch.zeros((n,) + src.shape[1:], dtype=src.dtype)
    return out.index_add_(0, seg, src)

def _pad(x, pw):
    flat = tuple((v for pair in reversed(pw) for v in pair))
    return torch.nn.functional.pad(x, flat)
kernel_name = 'adaLN_cond__ssm_conv_s4__dense_activation_silu__prompt'

def setup_inputs():

    _w = lambda a: (lambda t: t.to(torch.bfloat16) if t.is_floating_point() else t)(torch.as_tensor(a))

    def _A_setup():
        B, L, D, N = (1, 2048, 448, 256)
        A_re = -(lambda _x: torch.exp(torch.as_tensor(_x)))((lambda *s: torch.randn(*s, dtype=torch.bfloat16) * 3.2)(D, N))
        A_im = torch.pi * (lambda *s: torch.randn(*s, dtype=torch.bfloat16) * 0.05)(D, N)
        B_re = (lambda *s: torch.randn(*s, dtype=torch.bfloat16) * 0.1)(D, N)
        B_im = (lambda *s: torch.randn(*s, dtype=torch.bfloat16) * 0.1)(D, N)
        C_re = (lambda *s: torch.randn(*s, dtype=torch.bfloat16) * 0.1)(D, N)
        C_im = (lambda *s: torch.randn(*s, dtype=torch.bfloat16) * 0.1)(D, N)
        log_dt = (lambda *s: torch.randn(*s, dtype=torch.bfloat16) * 0.05)(D) * 0.5 - 4.0
        Dskip = (lambda *s: torch.randn(*s, dtype=torch.bfloat16) * 0.05)(D)
        return {'u': _w((lambda *s: torch.randn(*s, dtype=torch.bfloat16) * 0.05)(B, L, D)), 'A_re': _w(A_re), 'A_im': _w(A_im), 'B_re': _w(B_re), 'B_im': _w(B_im), 'C_re': _w(C_re), 'C_im': _w(C_im), 'log_dt': _w(log_dt), 'Dskip': _w(Dskip)}
    _A_in = _A_setup()

    def _B_setup():
        B, S, D, F = (1, 2048, 448, 1792)
        return {'x': _w((lambda *s: torch.randn(*s, dtype=torch.bfloat16) * 0.05)(B, S, D)), 'w1': _w((lambda *s: torch.randn(*s, dtype=torch.bfloat16) * 3.2)(D, F) * D ** (-0.5)), 'w2': _w((lambda *s: torch.randn(*s, dtype=torch.bfloat16) * 0.4)(F, D) * F ** (-0.5))}
    _B_in = _B_setup()
    return {'A_u': _A_in['u'], 'A_A_re': _A_in['A_re'], 'A_A_im': _A_in['A_im'], 'A_B_re': _A_in['B_re'], 'A_B_im': _A_in['B_im'], 'A_C_re': _A_in['C_re'], 'A_C_im': _A_in['C_im'], 'A_log_dt': _A_in['log_dt'], 'A_Dskip': _A_in['Dskip'], 'B_x': _B_in['x'], 'B_w1': _B_in['w1'], 'B_w2': _B_in['w2'], 'c': _w((lambda *s: torch.randn(*s, dtype=torch.bfloat16) * 0.2)(1, 448) * 8.0), 'w_mod': _w((lambda *s: torch.randn(*s, dtype=torch.bfloat16) * 0.2)(448, 6 * 448) * 448 ** (-0.5) * 8.0)}

def reference(A_u, A_A_re, A_A_im, A_B_re, A_B_im, A_C_re, A_C_im, A_log_dt, A_Dskip, B_x, B_w1, B_w2, c, w_mod):

    def _A_ref(u, A_re, A_im, B_re, B_im, C_re, C_im, log_dt, Dskip):
        Bsz, L, D = u.shape
        dt = torch.exp(log_dt)[:, None]
        A = A_re + 1j * A_im
        Bc = B_re + 1j * B_im
        Cc = C_re + 1j * C_im
        logdA = dt * A
        dB = dt * Bc
        l = (lambda x, dt: x.to(dt))(torch.arange(L), A_re.dtype)
        P = torch.exp(logdA[:, :, None] * l[None, None, :])
        K = torch.einsum('dn,dnl,dn->dl', Cc, P, dB).real
        L2 = 2 * L
        Kp = _pad(K, ((0, 0), (0, L)))
        up = (lambda x, *d: x.permute(*d))(u, 0, 2, 1)
        up = _pad(up, ((0, 0), (0, 0), (0, L)))
        Kf = (lambda x, axes=(-2, -1): torch.fft.rfft2(x.float(), dim=axes))(Kp[:, None, :], axes=(-2, -1))
        Uf = (lambda x, axes=(-2, -1): torch.fft.rfft2(x.float(), dim=axes))(up[:, :, None, :], axes=(-2, -1))
        Yf = Uf * Kf[None, :, :, :]
        y = (lambda x, s, axes=(-2, -1): torch.fft.irfft2(x, s=s, dim=axes).to(torch.bfloat16))(Yf, (1, L2), axes=(-2, -1))[:, :, 0, :L]
        y = (lambda x, *d: x.permute(*d))(y, 0, 2, 1) + u * Dskip[None, None, :]
        return y

    def _B_ref(x, w1, w2):
        h = torch.einsum('bsd,df->bsf', x, w1)
        h = _silu(h)
        out = torch.einsum('bsf,fd->bsd', h, w2)
        return out
    x = A_u
    mod = (_silu(c) @ w_mod).reshape(c.shape[0], 6, 1, -1)
    sa, ca, ga, sb, cb, gb = (mod[:, 0].clone(), mod[:, 1].clone(), mod[:, 2].clone(), mod[:, 3].clone(), mod[:, 4].clone(), mod[:, 5].clone())
    h = _layernorm(x, axis=-1) * (1 + ca) + sa
    x = x + ga * _A_ref(h, A_A_re, A_A_im, A_B_re, A_B_im, A_C_re, A_C_im, A_log_dt, A_Dskip)
    h = _layernorm(x, axis=-1) * (1 + cb) + sb
    x = x + gb * _B_ref(h, B_w1, B_w2)
    return x
```

```asm
; @launch grid=(256,1,1) block=(256,1,1) lds=145600
.amdgcn_target "amdgcn-amd-amdhsa--gfx950"
.text
.globl adaLN_cond__ssm_conv_s4__dense_activation_silu__prompt_kernel
.p2align 8
.type adaLN_cond__ssm_conv_s4__dense_activation_silu__prompt_kernel,@function
adaLN_cond__ssm_conv_s4__dense_activation_silu__prompt_kernel:

    s_getpc_b64 s[20:21]
F_pc:
    s_load_dwordx4 s[76:79], s[0:1], 120
    s_lshr_b32 s3, s2, 3
    s_lshl_b32 s3, s3, 10
    v_and_b32 v254, 15, v0
    v_lshl_add_u32 v254, v254, 6, s3
    v_min_u32 v254, code_end - F_pc - 4, v254
    s_cmp_ge_u32 s2, 256
    s_cbranch_scc1 F_end
    global_load_dword v254, v254, s[20:21]
    v_lshrrev_b32 v1, 6, v0
    s_load_dwordx4 s[64:67], s[0:1], 96
    s_cmp_ge_u32 s2, 224
    v_readfirstlane_b32 s6, v1
    s_cbranch_scc1 F_spare
    s_load_dwordx2 s[60:61], s[0:1], 0
    s_load_dwordx4 s[44:47], s[0:1], 8
    s_load_dwordx8 s[48:55], s[0:1], 24
    s_load_dwordx4 s[56:59], s[0:1], 56
    s_load_dwordx2 s[10:11], s[0:1], 112
    s_lshl_b32 s3, s2, 10
    v_lshl_add_u32 v2, v0, 2, s3
    v_and_b32 v3, 63, v0
    v_lshlrev_b32 v1, 4, v3
    s_lshr_b32 s38, s6, 1
    s_lshl_b32 s3, s2, 1
    s_add_u32 s3, s3, s38
    s_lshl_b32 s3, s3, 1
    v_mov_b32 v123, s3
    s_mov_b32 s63, 0x20000
    s_mov_b32 s71, 0x20000
    s_mov_b32 s75, 0x20000
    s_cmp_ge_u32 s2, 128
    s_cbranch_scc1 F_ld_mod
    s_mul_i32 s7, s2, 14336
    s_mul_i32 s16, s6, 3584
    s_add_u32 s7, s7, s16
    v_mov_b32 v5, 0x40000000
    v_cmp_gt_u32 s[16:17], 56, v3
    s_mov_b32 s62, 1835008
    s_nop 0
    v_cndmask_b32 v4, v5, v1, s[16:17]
    s_waitcnt lgkmcnt(0)
    buffer_load_dwordx4 v[170:173], v4, s[60:63], s7 offen offset:0
    buffer_load_dwordx4 v[174:177], v4, s[60:63], s7 offen offset:896
    buffer_load_dwordx4 v[178:181], v4, s[60:63], s7 offen offset:1792
    buffer_load_dwordx4 v[182:185], v4, s[60:63], s7 offen offset:2688
    global_load_dword v10, v2, s[44:45]
    global_load_dword v11, v2, s[46:47]
    global_load_dword v12, v2, s[48:49]
    global_load_dword v13, v2, s[50:51]
    global_load_dword v14, v2, s[52:53]
    global_load_dword v15, v2, s[54:55]
    global_load_ushort v124, v123, s[56:57]
    global_load_ushort v125, v123, s[58:59]
    s_branch F_ld_par
F_ld_mod:
    v_and_b32 v5, 3, v0
    v_lshrrev_b32 v8, 2, v0
    v_mul_u32_u24 v4, 5376, v8
    v_lshl_add_u32 v4, v5, 4, v4
    v_cmp_gt_u32 s[16:17], 32, v8
    v_lshlrev_b32 v8, 1, v8
    v_mov_b32 v9, 0x40000000
    v_cndmask_b32 v190, v9, v4, s[16:17]
    v_cndmask_b32 v191, v9, v8, s[16:17]
    s_sub_u32 s7, s2, 128
    s_and_b32 s34, s7, 1
    s_lshr_b32 s7, s7, 1
    s_lshl_b32 s7, s7, 6
    s_mul_i32 s35, s34, 1204224
    s_add_u32 s7, s7, s35
    s_mul_i32 s35, s34, 448
    s_mov_b32 s70, 896
    s_mov_b32 s74, 2408448
    s_cmp_ge_u32 s2, 212
    s_cselect_b32 s74, 0, s74
    s_waitcnt lgkmcnt(0)
    s_mov_b32 s68, s64
    s_mov_b32 s69, s65
    s_mov_b32 s72, s66
    s_mov_b32 s73, s67
    global_load_dword v10, v2, s[44:45]
    global_load_dword v11, v2, s[46:47]
    global_load_dword v12, v2, s[48:49]
    global_load_dword v13, v2, s[50:51]
    global_load_dword v14, v2, s[52:53]
    global_load_dword v15, v2, s[54:55]
    global_load_ushort v124, v123, s[56:57]
    global_load_ushort v125, v123, s[58:59]
    buffer_load_dwordx4 v[170:173], v4, s[72:75], s7 offen
    s_add_u32 s7, s7, 344064
    buffer_load_dwordx4 v[174:177], v4, s[72:75], s7 offen
    s_add_u32 s7, s7, 344064
    buffer_load_dwordx4 v[178:181], v4, s[72:75], s7 offen
    s_add_u32 s7, s7, 344064
    buffer_load_dwordx4 v[182:185], v190, s[72:75], s7 offen
    buffer_load_ushort v186, v8, s[68:71], s35 offen offset:0
    buffer_load_ushort v187, v8, s[68:71], s35 offen offset:128
    buffer_load_ushort v188, v8, s[68:71], s35 offen offset:256
    buffer_load_ushort v189, v191, s[68:71], s35 offen offset:384
F_ld_par:
    s_mov_b32 s8, s78
    s_mov_b32 s9, s79
    s_mul_i32 s39, s38, 54272
    v_and_b32 v7, 127, v0
    v_lshlrev_b32 v7, 3, v7
    v_add_u32 v160, s39, v7
    v_xor_b32 v161, 32, v160
    v_xor_b32 v162, 64, v160
    v_xor_b32 v163, 96, v160
    v_xor_b32 v164, 128, v160
    v_xor_b32 v165, 160, v160
    v_xor_b32 v166, 192, v160
    v_xor_b32 v167, 224, v160
    v_mov_b32 v153, 0
    s_lshl_b32 s3, s2, 6
    s_add_u32 s3, s3, 2293760
    v_mov_b32 v150, s3
    s_lshr_b32 s3, s2, 3
    s_mul_hi_u32 s4, s3, 0x24924925
    s_mul_i32 s5, s4, 7
    s_sub_u32 s5, s3, s5
    s_and_b32 s3, s2, 7
    s_lshl_b32 s3, s3, 2
    s_add_u32 s4, s4, s3
    s_mov_b32 s12, s8
    s_mov_b32 s13, s9
    s_mov_b32 s14, 0x10000000
    s_mov_b32 s15, 0x20000
    s_lshl_b32 s17, s5, 2
    s_add_u32 s17, s17, s6
    s_mul_i32 s17, s17, 57344
    s_add_u32 s18, s17, 3145728
    s_add_u32 s19, s17, 5242880
    s_cmp_eq_u32 s38, 0
    s_cselect_b32 s67, 16, 0
    v_bfe_u32 v6, v0, 5, 1
    v_mov_b32 v122, 1069066811
    v_mov_b32 v126, 1042479491
    v_mov_b32 v8, 0
    v_mov_b32 v9, 0
    v_mov_b32 v28, 108552
    ds_write2_b64 v28, v[8:9], v[8:9] offset0:0 offset1:192
    v_lshlrev_b32 v28, 3, v0
    v_sub_u32 v28, 2047, v28
    v_cvt_f32_i32 v44, v28
    s_mov_b32 s43, 74512
    v_subrev_f32 v45, 0x3f800000, v44
    v_subrev_f32 v46, 0x40000000, v44
    v_subrev_f32 v47, 0x40400000, v44
    v_subrev_f32 v48, 0x40800000, v44
    v_subrev_f32 v49, 0x40a00000, v44
    v_subrev_f32 v50, 0x40c00000, v44
    v_subrev_f32 v51, 0x40e00000, v44
    v_subrev_f32 v52, 0x41000000, v44
    v_cvt_pk_bf16_f32 v44, v44, v45
    v_cvt_pk_bf16_f32 v46, v46, v47
    v_cvt_pk_bf16_f32 v48, v48, v49
    v_cvt_pk_bf16_f32 v50, v50, v51
    v_cvt_pk_bf16_f32 v52, v52, v52
    v_mad_u32_u16 v30, v44, 2, s43
    v_mad_u32_u16 v31, v44, 2, s43 op_sel:[1,0,0,0]
    v_mad_u32_u16 v32, v46, 2, s43
    v_mad_u32_u16 v33, v46, 2, s43 op_sel:[1,0,0,0]
    v_mad_u32_u16 v34, v48, 2, s43
    v_mad_u32_u16 v35, v48, 2, s43 op_sel:[1,0,0,0]
    v_mad_u32_u16 v36, v50, 2, s43
    v_mad_u32_u16 v37, v50, 2, s43 op_sel:[1,0,0,0]
    v_mad_u32_u16 v38, v52, 2, s43
    s_cmp_lg_u32 s6, 3
    s_cbranch_scc1 F_nolin
    s_mov_b32 exec_lo, 0
    v_lshlrev_b32 v30, 1, v28
    v_add_u32 v30, 108560, v30
    v_subrev_u32 v31, 2, v30
    v_subrev_u32 v32, 4, v30
    v_subrev_u32 v33, 6, v30
    v_subrev_u32 v34, 8, v30
    v_subrev_u32 v35, 10, v30
    v_subrev_u32 v36, 12, v30
    v_subrev_u32 v37, 14, v30
    v_subrev_u32 v38, 16, v30
    s_mov_b64 exec, -1
F_nolin:
    s_mul_i32 s42, s38, 1536
    s_add_u32 s42, s42, 108560
    v_and_b32 v56, 15, v0
    v_bfe_u32 v57, v0, 4, 2
    s_bitcmp1_b32 s6, 0
    s_cbranch_scc1 F_kd_xt1
    v_cmp_eq_u32 s[16:17], 2, v57
    v_cmp_eq_u32 s[22:23], 3, v57
    v_lshlrev_b32 v40, 3, v56
    v_lshl_add_u32 v40, v57, 2, v40
    v_lshlrev_b32 v47, 2, v56
    v_add_u32 v47, 256, v47
    v_lshlrev_b32 v48, 1, v56
    v_add_u32 v48, 384, v48
    v_cndmask_b32 v40, v40, v47, s[16:17]
    v_cndmask_b32 v40, v40, v48, s[22:23]
    v_lshl_add_u32 v40, v40, 1, s42
    v_add_u32 v46, 4, v40
    v_add_u32 v47, 128, v40
    v_add_u32 v41, 2, v40
    v_cndmask_b32 v42, v46, v47, s[22:23]
    v_max_u32 v48, 1, v57
    v_add_u32 v43, 2, v42
    s_movk_i32 s43, 0x200
    v_lshrrev_b32 v48, v48, s43
    s_branch F_kd_done
F_kd_xt1:
    v_cmp_eq_u32 s[22:23], 0, v57
    v_cmp_eq_u32 s[16:17], 16, v3
    s_add_u32 s43, s42, 1024
    v_lshl_add_u32 v46, v56, 1, s43
    s_add_u32 s43, s42, 1400
    v_mov_b32 v47, s43
    s_add_u32 s43, s42, 1280
    v_mov_b32 v48, s43
    v_cndmask_b32 v48, v47, v48, s[16:17]
    v_cndmask_b32 v40, v48, v46, s[22:23]
    v_add_u32 v46, 64, v46
    v_cndmask_b32 v41, v47, v46, s[22:23]
    v_add_u32 v46, 64, v46
    v_cndmask_b32 v42, v47, v46, s[22:23]
    v_add_u32 v46, 64, v46
    v_cndmask_b32 v43, v47, v46, s[22:23]
    v_mov_b32 v48, 32
F_kd_done:
    v_add_u32 v44, v48, v40
    v_add_u32 v45, v48, v41
    v_add_u32 v46, v48, v42
    v_add_u32 v47, v48, v43
    s_and_b32 s16, s6, 1
    s_lshl_b32 s16, s16, 14
    s_add_u32 s16, s16, s39
    v_lshl_add_u32 v58, v56, 10, s16
    v_and_b32 v59, 7, v56
    v_lshlrev_b32 v59, 1, v59
    v_xor_b32 v59, v59, v57
    v_lshl_add_u32 v216, v59, 4, v58
    v_add_u32 v58, 21, v56
    v_and_b32 v59, 7, v58
    v_lshl_add_u32 v58, v58, 10, s39
    v_lshlrev_b32 v59, 1, v59
    v_xor_b32 v59, v59, v57
    v_lshl_add_u32 v220, v59, 4, v58
    v_xor_b32 v217, 64, v216
    v_xor_b32 v221, 64, v220
    v_xor_b32 v218, 128, v216
    v_xor_b32 v222, 128, v220
    v_xor_b32 v219, 192, v216
    v_xor_b32 v223, 192, v220
    s_lshl_b32 s16, s5, 2
    s_add_u32 s16, s16, s6
    s_lshl_b32 s16, s16, 6
    s_add_u32 s16, s16, 2392064
    v_mov_b32 v252, s16
    s_cmp_ge_u32 s2, 128
    s_cbranch_scc1 F_nostats
    s_mul_i32 s16, s6, 3840
    s_add_u32 s16, s16, 111616
    v_add_u32 v210, s16, v1
    v_bfe_u32 v211, v0, 2, 2
    v_lshl_add_u32 v211, v6, 3, v211
    v_mul_u32_u24 v211, 960, v211
    v_and_b32 v213, 3, v0
    v_lshl_add_u32 v211, v213, 3, v211
    v_bfe_u32 v213, v0, 4, 1
    v_lshl_add_u32 v211, v213, 5, v211
    s_lshl_b32 s16, s6, 6
    s_add_u32 s16, s16, 111616
    v_add_u32 v211, s16, v211
    v_bfe_u32 v212, v0, 1, 3
    v_lshl_add_u32 v212, v213, 3, v212
    v_mul_u32_u24 v212, 8320, v212
    v_lshl_add_u32 v214, v213, 1, v6
    v_and_b32 v213, 1, v0
    v_lshl_add_u32 v212, v213, 5, v212
    v_lshl_add_u32 v212, v6, 4, v212
    s_mul_i32 s16, s6, 133120
    s_lshl_b32 s17, s2, 6
    s_add_u32 s16, s16, s17
    v_add_u32 v212, s16, v212
    s_lshl_b32 s16, s6, 4
    s_add_u32 s16, s16, s17
    s_add_u32 s16, s16, 2097152
    v_lshl_add_u32 v214, v214, 2, s16
    s_mov_b32 s16, 0x3f803f80
    s_mov_b32 s22, -1
    s_mov_b32 s23, 0x00ffffff
    v_mov_b32 v186, 0
    v_mov_b32 v187, 0
    v_mov_b32 v188, 0
    v_mov_b32 v189, 0
    v_mov_b32 v190, 0
    v_mov_b32 v191, 0
    v_mov_b32 v192, 0
    v_mov_b32 v193, 0
    s_waitcnt vmcnt(8)
    s_mov_b64 exec, s[22:23]
    ds_write_b128 v210, v[170:173] offset:0
    ds_write_b128 v210, v[174:177] offset:960
    ds_write_b128 v210, v[178:181] offset:1920
    ds_write_b128 v210, v[182:185] offset:2880
    s_mov_b64 exec, -1
    v_dot2c_f32_bf16 v186, s16, v170
    v_dot2c_f32_bf16 v190, v170, v170
    v_dot2c_f32_bf16 v187, s16, v174
    v_dot2c_f32_bf16 v191, v174, v174
    v_dot2c_f32_bf16 v188, s16, v178
    v_dot2c_f32_bf16 v192, v178, v178
    v_dot2c_f32_bf16 v189, s16, v182
    v_dot2c_f32_bf16 v193, v182, v182
    s_waitcnt lgkmcnt(0)
    s_barrier
    ds_read_b64_tr_b16 v[194:195], v211 offset:0
    ds_read_b64_tr_b16 v[196:197], v211 offset:3840
    ds_read_b64_tr_b16 v[198:199], v211 offset:256
    ds_read_b64_tr_b16 v[200:201], v211 offset:4096
    ds_read_b64_tr_b16 v[202:203], v211 offset:512
    ds_read_b64_tr_b16 v[204:205], v211 offset:4352
    ds_read_b64_tr_b16 v[206:207], v211 offset:768
    ds_read_b64_tr_b16 v[208:209], v211 offset:4608
    v_dot2c_f32_bf16 v186, s16, v171
    v_dot2c_f32_bf16 v190, v171, v171
    v_dot2c_f32_bf16 v187, s16, v175
    v_dot2c_f32_bf16 v191, v175, v175
    v_dot2c_f32_bf16 v188, s16, v179
    v_dot2c_f32_bf16 v192, v179, v179
    v_dot2c_f32_bf16 v189, s16, v183
    v_dot2c_f32_bf16 v193, v183, v183
    s_waitcnt vmcnt(0) lgkmcnt(6)
    global_store_dwordx4 v212, v[194:197], s[8:9] sc1
    v_add_u32 v212, 532480, v212
    s_waitcnt lgkmcnt(4)
    global_store_dwordx4 v212, v[198:201], s[8:9] sc1
    v_add_u32 v212, 532480, v212
    s_waitcnt lgkmcnt(2)
    global_store_dwordx4 v212, v[202:205], s[8:9] sc1
    v_add_u32 v212, 532480, v212
    s_cmp_ge_u32 s6, 2
    s_cbranch_scc1 F_st_skip
    s_waitcnt lgkmcnt(0)
    global_store_dwordx4 v212, v[206:209], s[8:9] sc1
F_st_skip:
    v_dot2c_f32_bf16 v186, s16, v172
    v_dot2c_f32_bf16 v190, v172, v172
    v_dot2c_f32_bf16 v187, s16, v176
    v_dot2c_f32_bf16 v191, v176, v176
    v_dot2c_f32_bf16 v188, s16, v180
    v_dot2c_f32_bf16 v192, v180, v180
    v_dot2c_f32_bf16 v189, s16, v184
    v_dot2c_f32_bf16 v193, v184, v184
    v_dot2c_f32_bf16 v186, s16, v173
    v_dot2c_f32_bf16 v190, v173, v173
    v_dot2c_f32_bf16 v187, s16, v177
    v_dot2c_f32_bf16 v191, v177, v177
    v_dot2c_f32_bf16 v188, s16, v181
    v_dot2c_f32_bf16 v192, v181, v181
    v_dot2c_f32_bf16 v189, s16, v185
    v_dot2c_f32_bf16 v193, v185, v185
    v_permlane32_swap_b32 v186, v187
    s_nop 0
    v_permlane32_swap_b32 v188, v189
    v_permlane32_swap_b32 v190, v191
    v_permlane32_swap_b32 v192, v193
    v_add_f32 v186, v186, v187
    v_add_f32 v188, v188, v189
    v_add_f32 v190, v190, v191
    v_add_f32 v192, v192, v193
    v_permlane16_swap_b32 v186, v188
    s_nop 0
    v_permlane16_swap_b32 v190, v192
    v_add_f32 v186, v186, v188
    v_add_f32 v190, v190, v192
    s_nop 0
    v_add_f32_dpp v186, v186, v186 row_ror:8 row_mask:0xf bank_mask:0xf
    v_add_f32_dpp v190, v190, v190 row_ror:8 row_mask:0xf bank_mask:0xf
    s_nop 0
    v_add_f32_dpp v186, v186, v186 row_ror:4 row_mask:0xf bank_mask:0xf
    v_add_f32_dpp v190, v190, v190 row_ror:4 row_mask:0xf bank_mask:0xf
    s_nop 0
    v_add_f32_dpp v186, v186, v186 row_ror:2 row_mask:0xf bank_mask:0xf
    v_add_f32_dpp v190, v190, v190 row_ror:2 row_mask:0xf bank_mask:0xf
    s_nop 0
    v_add_f32_dpp v186, v186, v186 row_ror:1 row_mask:0xf bank_mask:0xf
    v_add_f32_dpp v190, v190, v190 row_ror:1 row_mask:0xf bank_mask:0xf
    v_mul_f32 v186, 991054117, v186
    v_mul_f32 v190, 991054117, v190
    v_fma_f32 v190, -v186, v186, v190
    v_max_f32 v190, 0, v190
    v_cvt_pk_bf16_f32 v190, 0, v190
    v_add_f32 v190, 925353388, v190
    v_cvt_pk_bf16_f32 v190, 0, v190
    v_sqrt_f32 v190, v190
    s_mov_b32 exec_lo, 0x00010001
    s_mov_b32 exec_hi, 0x00010001
    v_cvt_pk_bf16_f32 v190, v186, v190
    global_store_dword v214, v190, s[8:9] sc1
    s_mov_b64 exec, -1
    s_branch F_par_ok
F_nostats:
    s_waitcnt vmcnt(8)
F_par_ok:
    global_load_dword v151, v153, s[76:77] sc1
    v_lshlrev_b32 v124, 16, v124
    v_lshlrev_b32 v125, 16, v125
    v_mul_f32 v124, v122, v124
    v_exp_f32 v124, v124
    v_readfirstlane_b32 s29, v125
    v_lshlrev_b32 v128, 16, v10
    v_and_b32 v129, 0xffff0000, v10
    v_lshlrev_b32 v130, 16, v11
    v_and_b32 v131, 0xffff0000, v11
    v_lshlrev_b32 v132, 16, v12
    v_and_b32 v133, 0xffff0000, v12
    v_lshlrev_b32 v134, 16, v13
    v_and_b32 v135, 0xffff0000, v13
    v_lshlrev_b32 v136, 16, v14
    v_and_b32 v137, 0xffff0000, v14
    v_lshlrev_b32 v138, 16, v15
    v_and_b32 v139, 0xffff0000, v15
    v_cvt_pk_bf16_f32 v124, 0, v124
    v_pk_mul_f32 v[128:129], v[128:129], v[124:125] op_sel_hi:[1,0]
    v_pk_mul_f32 v[130:131], v[130:131], v[124:125] op_sel_hi:[1,0]
    v_pk_mul_f32 v[132:133], v[132:133], v[124:125] op_sel_hi:[1,0]
    v_pk_mul_f32 v[134:135], v[134:135], v[124:125] op_sel_hi:[1,0]
    v_mov_b32 v140, 0x41000000
    v_mov_b32 v142, 0x43800000
    v_pk_mul_f32 v[128:129], v[128:129], v[122:123] op_sel_hi:[1,0]
    v_pk_mul_f32 v[130:131], v[130:131], v[126:127] op_sel_hi:[1,0]
    v_pk_mul_f32 v[50:51], v[136:137], v[132:133]
    v_pk_mul_f32 v[52:53], v[136:137], v[134:135]
    v_pk_mul_f32 v[144:145], v[128:129], v[140:141] op_sel_hi:[1,0]
    v_pk_mul_f32 v[146:147], v[130:131], v[140:141] op_sel_hi:[1,0]
    v_pk_mul_f32 v[148:149], v[128:129], v[142:143] op_sel_hi:[1,0]
    v_pk_mul_f32 v[154:155], v[130:131], v[142:143] op_sel_hi:[1,0]
    v_pk_fma_f32 v[50:51], v[138:139], v[134:135], v[50:51] neg_lo:[1,0,0] neg_hi:[1,0,0]
    v_pk_fma_f32 v[52:53], v[138:139], v[132:133], v[52:53]
    v_fract_f32 v146, v146
    v_fract_f32 v147, v147
    v_fract_f32 v130, v130
    v_fract_f32 v131, v131
    v_fract_f32 v154, v154
    v_fract_f32 v155, v155
    v_exp_f32 v144, v144
    v_exp_f32 v145, v145
    v_cos_f32 v58, v146
    v_cos_f32 v59, v147
    v_sin_f32 v60, v146
    v_sin_f32 v61, v147
    v_exp_f32 v128, v128
    v_exp_f32 v129, v129
    v_cos_f32 v54, v130
    v_cos_f32 v55, v131
    v_sin_f32 v56, v130
    v_sin_f32 v57, v131
    v_exp_f32 v148, v148
    v_exp_f32 v149, v149
    v_cos_f32 v62, v154
    v_cos_f32 v63, v155
    v_sin_f32 v64, v154
    v_sin_f32 v65, v155
    v_mov_b32 v156, 0x3f80
    v_mov_b32 v157, 0x3f80
    v_pk_mul_f32 v[58:59], v[58:59], v[144:145]
    v_pk_mul_f32 v[60:61], v[60:61], v[144:145] neg_lo:[1,0] neg_hi:[1,0]
    v_pk_mul_f32 v[54:55], v[54:55], v[128:129]
    v_pk_mul_f32 v[56:57], v[56:57], v[128:129]
    v_pk_mul_f32 v[62:63], v[62:63], v[148:149]
    v_pk_mul_f32 v[64:65], v[64:65], v[148:149]
    v_pk_mul_f32 v[66:67], v[58:59], v[58:59]
    v_cvt_pk_bf16_f32 v128, v50, v52
    v_pk_mul_f32 v[70:71], v[50:51], v[54:55]
    v_cvt_pk_bf16_f32 v129, v51, v53
    v_pk_mul_f32 v[68:69], v[58:59], v[60:61]
    v_cvt_pk_bf16_f32 v130, v58, v60
    v_pk_mul_f32 v[72:73], v[50:51], v[56:57]
    v_cvt_pk_bf16_f32 v131, v59, v61
    v_pk_fma_f32 v[66:67], v[60:61], v[60:61], v[66:67] neg_lo:[1,0,0] neg_hi:[1,0,0]
    v_pk_fma_f32 v[70:71], v[52:53], v[56:57], v[70:71] neg_lo:[1,0,0] neg_hi:[1,0,0]
    v_pk_fma_f32 v[68:69], v[60:61], v[58:59], v[68:69]
    v_pk_fma_f32 v[72:73], v[52:53], v[54:55], v[72:73]
    v_pk_mul_f32 v[106:107], v[58:59], v[66:67]
    v_cvt_pk_bf16_f32 v132, v66, v68
    v_pk_mul_f32 v[114:115], v[66:67], v[66:67]
    v_cvt_pk_bf16_f32 v133, v67, v69
    v_pk_mul_f32 v[74:75], v[70:71], v[54:55]
    v_cvt_pk_bf16_f32 v134, v70, v72
    v_pk_mul_f32 v[108:109], v[58:59], v[68:69]
    v_cvt_pk_bf16_f32 v135, v71, v73
    v_pk_mul_f32 v[116:117], v[66:67], v[68:69]
    v_pk_mul_f32 v[76:77], v[70:71], v[56:57]
    v_pk_fma_f32 v[106:107], v[60:61], v[68:69], v[106:107] neg_lo:[1,0,0] neg_hi:[1,0,0]
    v_pk_fma_f32 v[114:115], v[68:69], v[68:69], v[114:115] neg_lo:[1,0,0] neg_hi:[1,0,0]
    v_pk_fma_f32 v[74:75], v[72:73], v[56:57], v[74:75] neg_lo:[1,0,0] neg_hi:[1,0,0]
    v_pk_fma_f32 v[108:109], v[60:61], v[66:67], v[108:109]
    v_pk_fma_f32 v[116:117], v[68:69], v[66:67], v[116:117]
    v_pk_fma_f32 v[76:77], v[72:73], v[54:55], v[76:77]
    v_pk_mul_f32 v[110:111], v[106:107], v[66:67]
    v_cvt_pk_bf16_f32 v136, v106, v108
    v_pk_mul_f32 v[118:119], v[114:115], v[66:67]
    v_cvt_pk_bf16_f32 v137, v107, v109
    v_pk_mul_f32 v[78:79], v[74:75], v[54:55]
    v_cvt_pk_bf16_f32 v138, v114, v116
    v_pk_mul_f32 v[112:113], v[106:107], v[68:69]
    v_cvt_pk_bf16_f32 v139, v115, v117
    v_pk_mul_f32 v[120:121], v[114:115], v[68:69]
    ds_write2st64_b64 v160, v[128:129], v[136:137] offset0:0 offset1:48
    v_pk_mul_f32 v[80:81], v[74:75], v[56:57]
    v_cvt_pk_bf16_f32 v140, v74, v76
    v_pk_fma_f32 v[110:111], v[108:109], v[68:69], v[110:111] neg_lo:[1,0,0] neg_hi:[1,0,0]
    v_cvt_pk_bf16_f32 v141, v75, v77
    v_pk_fma_f32 v[118:119], v[116:117], v[68:69], v[118:119] neg_lo:[1,0,0] neg_hi:[1,0,0]
    ds_write2st64_b64 v161, v[134:135], v[138:139] offset0:2 offset1:50
    v_pk_fma_f32 v[78:79], v[76:77], v[56:57], v[78:79] neg_lo:[1,0,0] neg_hi:[1,0,0]
    v_pk_fma_f32 v[112:113], v[108:109], v[66:67], v[112:113]
    v_pk_fma_f32 v[120:121], v[116:117], v[66:67], v[120:121]
    v_pk_fma_f32 v[80:81], v[76:77], v[54:55], v[80:81]
    v_pk_mul_f32 v[106:107], v[110:111], v[66:67]
    v_cvt_pk_bf16_f32 v142, v110, v112
    v_pk_mul_f32 v[114:115], v[118:119], v[66:67]
    v_cvt_pk_bf16_f32 v143, v111, v113
    v_pk_mul_f32 v[82:83], v[78:79], v[54:55]
    v_cvt_pk_bf16_f32 v144, v118, v120
    v_pk_mul_f32 v[108:109], v[110:111], v[68:69]
    v_cvt_pk_bf16_f32 v145, v119, v121
    v_pk_mul_f32 v[116:117], v[118:119], v[68:69]
    ds_write2st64_b64 v162, v[140:141], v[142:143] offset0:4 offset1:52
    v_pk_mul_f32 v[84:85], v[78:79], v[56:57]
    v_cvt_pk_bf16_f32 v146, v78, v80
    v_pk_fma_f32 v[106:107], v[112:113], v[68:69], v[106:107] neg_lo:[1,0,0] neg_hi:[1,0,0]
    v_cvt_pk_bf16_f32 v147, v79, v81
    v_pk_fma_f32 v[114:115], v[120:121], v[68:69], v[114:115] neg_lo:[1,0,0] neg_hi:[1,0,0]
    v_pk_fma_f32 v[82:83], v[80:81], v[56:57], v[82:83] neg_lo:[1,0,0] neg_hi:[1,0,0]
    ds_write2st64_b64 v163, v[144:145], v[146:147] offset0:54 offset1:6
    v_pk_fma_f32 v[108:109], v[112:113], v[66:67], v[108:109]
    v_pk_fma_f32 v[116:117], v[120:121], v[66:67], v[116:117]
    v_pk_fma_f32 v[84:85], v[80:81], v[54:55], v[84:85]
    v_pk_mul_f32 v[110:111], v[106:107], v[66:67]
    v_cvt_pk_bf16_f32 v148, v106, v108
    v_pk_mul_f32 v[118:119], v[114:115], v[66:67]
    v_cvt_pk_bf16_f32 v149, v107, v109
    v_pk_mul_f32 v[86:87], v[82:83], v[54:55]
    v_cvt_pk_bf16_f32 v224, v114, v116
    v_pk_mul_f32 v[112:113], v[106:107], v[68:69]
    v_cvt_pk_bf16_f32 v225, v115, v117
    v_pk_mul_f32 v[120:121], v[114:115], v[68:69]
    v_pk_mul_f32 v[88:89], v[82:83], v[56:57]
    v_cvt_pk_bf16_f32 v226, v82, v84
    v_pk_fma_f32 v[110:111], v[108:109], v[68:69], v[110:111] neg_lo:[1,0,0] neg_hi:[1,0,0]
    v_cvt_pk_bf16_f32 v227, v83, v85
    v_pk_fma_f32 v[118:119], v[116:117], v[68:69], v[118:119] neg_lo:[1,0,0] neg_hi:[1,0,0]
    ds_write2st64_b64 v165, v[156:157], v[224:225] offset0:42 offset1:58
    v_pk_fma_f32 v[86:87], v[84:85], v[56:57], v[86:87] neg_lo:[1,0,0] neg_hi:[1,0,0]
    ds_write2st64_b64 v164, v[148:149], v[226:227] offset0:56 offset1:8
    v_pk_fma_f32 v[112:113], v[108:109], v[66:67], v[112:113]
    v_pk_fma_f32 v[120:121], v[116:117], v[66:67], v[120:121]
    v_pk_fma_f32 v[88:89], v[84:85], v[54:55], v[88:89]
    v_pk_mul_f32 v[106:107], v[110:111], v[66:67]
    v_cvt_pk_bf16_f32 v228, v110, v112
    v_pk_mul_f32 v[114:115], v[118:119], v[66:67]
    v_cvt_pk_bf16_f32 v229, v111, v113
    v_pk_mul_f32 v[90:91], v[86:87], v[54:55]
    v_cvt_pk_bf16_f32 v230, v118, v120
    v_pk_mul_f32 v[108:109], v[110:111], v[68:69]
    v_cvt_pk_bf16_f32 v231, v119, v121
    v_pk_mul_f32 v[116:117], v[118:119], v[68:69]
    ds_write2st64_b64 v166, v[130:131], v[228:229] offset0:44 offset1:60
    v_pk_mul_f32 v[92:93], v[86:87], v[56:57]
    v_cvt_pk_bf16_f32 v232, v86, v88
    v_pk_fma_f32 v[106:107], v[112:113], v[68:69], v[106:107] neg_lo:[1,0,0] neg_hi:[1,0,0]
    v_cvt_pk_bf16_f32 v233, v87, v89
    v_pk_fma_f32 v[114:115], v[120:121], v[68:69], v[114:115] neg_lo:[1,0,0] neg_hi:[1,0,0]
    ds_write2st64_b64 v167, v[132:133], v[230:231] offset0:46 offset1:62
    v_pk_fma_f32 v[90:91], v[88:89], v[56:57], v[90:91] neg_lo:[1,0,0] neg_hi:[1,0,0]
    v_pk_fma_f32 v[108:109], v[112:113], v[66:67], v[108:109]
    v_pk_fma_f32 v[116:117], v[120:121], v[66:67], v[116:117]
    v_pk_fma_f32 v[92:93], v[88:89], v[54:55], v[92:93]
    s_cmp_lt_u32 s2, 128
    s_cbranch_scc1 F_nomod
    v_mov_b32 v194, 0
    v_mov_b32 v195, 0
    v_mov_b32 v196, 0
    v_mov_b32 v197, 0
    v_mov_b32 v198, 0
    v_mov_b32 v199, 0
    v_mov_b32 v200, 0
    v_mov_b32 v201, 0
    s_lshl_b32 s16, s6, 7
    s_add_u32 s16, s16, 111616
    v_lshl_add_u32 v210, v5, 5, s16
    v_bfe_u32 v211, v0, 4, 1
    v_lshl_add_u32 v210, v211, 3, v210
    v_bfe_u32 v211, v0, 5, 1
    v_lshl_add_u32 v210, v211, 2, v210
    s_mov_b32 s16, 3216550459
    s_waitcnt vmcnt(1)
    v_lshlrev_b32 v186, 16, v186
    v_lshlrev_b32 v187, 16, v187
    v_lshlrev_b32 v188, 16, v188
    v_lshlrev_b32 v189, 16, v189
    v_mul_f32 v190, s16, v186
    v_mul_f32 v191, s16, v187
    v_mul_f32 v192, s16, v188
    v_mul_f32 v193, s16, v189
    v_exp_f32 v190, v190
    v_exp_f32 v191, v191
    v_exp_f32 v192, v192
    v_exp_f32 v193, v193
    v_add_f32 v190, 1.0, v190
    v_add_f32 v191, 1.0, v191
    v_add_f32 v192, 1.0, v192
    v_add_f32 v193, 1.0, v193
    v_rcp_f32 v190, v190
    v_rcp_f32 v191, v191
    v_rcp_f32 v192, v192
    v_rcp_f32 v193, v193
    v_mul_f32 v186, v186, v190
    v_mul_f32 v187, v187, v191
    v_mul_f32 v188, v188, v192
    v_mul_f32 v189, v189, v193
    v_cvt_pk_bf16_f32 v186, v186, 0
    v_cvt_pk_bf16_f32 v187, v187, 0
    v_cvt_pk_bf16_f32 v188, v188, 0
    v_cvt_pk_bf16_f32 v189, v189, 0
    v_lshlrev_b32 v190, 16, v186
    v_lshlrev_b32 v191, 16, v187
    v_lshlrev_b32 v192, 16, v188
    v_lshlrev_b32 v193, 16, v189
    v_dot2c_f32_bf16 v194, v170, v186
    v_dot2c_f32_bf16 v195, v170, v190
    v_dot2c_f32_bf16 v196, v171, v186
    v_dot2c_f32_bf16 v197, v171, v190
    v_dot2c_f32_bf16 v198, v172, v186
    v_dot2c_f32_bf16 v199, v172, v190
    v_dot2c_f32_bf16 v200, v173, v186
    v_dot2c_f32_bf16 v201, v173, v190
    v_dot2c_f32_bf16 v194, v174, v187
    v_dot2c_f32_bf16 v195, v174, v191
    v_dot2c_f32_bf16 v196, v175, v187
    v_dot2c_f32_bf16 v197, v175, v191
    v_dot2c_f32_bf16 v198, v176, v187
    v_dot2c_f32_bf16 v199, v176, v191
    v_dot2c_f32_bf16 v200, v177, v187
    v_dot2c_f32_bf16 v201, v177, v191
    v_dot2c_f32_bf16 v194, v178, v188
    v_dot2c_f32_bf16 v195, v178, v192
    v_dot2c_f32_bf16 v196, v179, v188
    v_dot2c_f32_bf16 v197, v179, v192
    v_dot2c_f32_bf16 v198, v180, v188
    v_dot2c_f32_bf16 v199, v180, v192
    v_dot2c_f32_bf16 v200, v181, v188
    v_dot2c_f32_bf16 v201, v181, v192
    v_dot2c_f32_bf16 v194, v182, v189
    v_dot2c_f32_bf16 v195, v182, v193
    v_dot2c_f32_bf16 v196, v183, v189
    v_dot2c_f32_bf16 v197, v183, v193
    v_dot2c_f32_bf16 v198, v184, v189
    v_dot2c_f32_bf16 v199, v184, v193
    v_dot2c_f32_bf16 v200, v185, v189
    v_dot2c_f32_bf16 v201, v185, v193
    v_permlane32_swap_b32 v194, v195
    v_permlane32_swap_b32 v196, v197
    v_permlane32_swap_b32 v198, v199
    v_permlane32_swap_b32 v200, v201
    v_add_f32 v194, v194, v195
    v_add_f32 v196, v196, v197
    v_add_f32 v198, v198, v199
    v_add_f32 v200, v200, v201
    v_permlane16_swap_b32 v194, v196
    s_nop 0
    v_permlane16_swap_b32 v198, v200
    v_add_f32 v194, v194, v196
    v_add_f32 v198, v198, v200
    s_nop 0
    v_add_f32_dpp v194, v194, v194 row_ror:8 row_mask:0xf bank_mask:0xf
    v_add_f32_dpp v198, v198, v198 row_ror:8 row_mask:0xf bank_mask:0xf
    s_nop 0
    v_add_f32_dpp v194, v194, v194 row_ror:4 row_mask:0xf bank_mask:0xf
    v_add_f32_dpp v198, v198, v198 row_ror:4 row_mask:0xf bank_mask:0xf
    ds_write_b32 v210, v194
    ds_write_b32 v210, v198 offset:16
    s_waitcnt lgkmcnt(0)
    s_barrier
    s_cmp_lg_u32 s6, 3
    s_cbranch_scc1 F_nomod
    s_cmp_ge_u32 s2, 212
    s_cbranch_scc1 F_nomod
    s_mov_b32 exec_hi, 0
    v_lshlrev_b32 v210, 2, v3
    v_add_u32 v211, 111616, v210
    ds_read2_b32 v[170:171], v211 offset0:0 offset1:32
    ds_read2_b32 v[172:173], v211 offset0:64 offset1:96
    s_sub_u32 s16, s2, 128
    s_lshr_b32 s17, s16, 1
    s_lshl_b32 s17, s17, 8
    s_lshl_b32 s16, s34, 2
    s_add_u32 s17, s17, s16
    s_add_u32 s17, s17, 2424832
    v_lshl_add_u32 v212, v210, 1, s17
    s_waitcnt lgkmcnt(0)
    v_add_f32 v170, v170, v171
    v_add_f32 v172, v172, v173
    v_add_f32 v170, v170, v172
    global_store_dword v212, v170, s[8:9] sc1
    s_mov_b64 exec, -1
F_nomod:
    s_cmp_ge_u32 s2, 128
    s_cbranch_scc1 F_nopub
    s_waitcnt vmcnt(0)
    s_barrier
    v_readfirstlane_b32 s33, v151
    s_mov_b32 s35, 0
F_n0_l:
    s_cmp_lg_u32 s33, 0
    s_cbranch_scc1 F_n0_ok
    global_load_dword v151, v153, s[76:77] sc1
    s_add_u32 s35, s35, 1
    s_waitcnt vmcnt(0)
    v_readfirstlane_b32 s33, v151
    s_cmp_lt_u32 s35, 0x80000
    s_cbranch_scc1 F_n0_l
F_n0_ok:
    s_cmp_lg_u32 s6, 3
    s_cbranch_scc1 F_nopub
    s_mov_b64 exec, 1
    global_store_dword v150, v151, s[8:9] sc1
    s_mov_b64 exec, -1
F_nopub:
    v_pk_mul_f32 v[110:111], v[106:107], v[66:67]
    v_cvt_pk_bf16_f32 v234, v106, v108
    v_pk_mul_f32 v[118:119], v[114:115], v[66:67]
    v_cvt_pk_bf16_f32 v235, v107, v109
    v_pk_mul_f32 v[94:95], v[90:91], v[54:55]
    v_cvt_pk_bf16_f32 v236, v114, v116
    v_pk_mul_f32 v[112:113], v[106:107], v[68:69]
    v_cvt_pk_bf16_f32 v237, v115, v117
    v_pk_mul_f32 v[120:121], v[114:115], v[68:69]
    v_pk_mul_f32 v[96:97], v[90:91], v[56:57]
    v_cvt_pk_bf16_f32 v238, v90, v92
    v_pk_fma_f32 v[110:111], v[108:109], v[68:69], v[110:111] neg_lo:[1,0,0] neg_hi:[1,0,0]
    v_cvt_pk_bf16_f32 v239, v91, v93
    v_pk_fma_f32 v[118:119], v[116:117], v[68:69], v[118:119] neg_lo:[1,0,0] neg_hi:[1,0,0]
    v_pk_fma_f32 v[94:95], v[92:93], v[56:57], v[94:95] neg_lo:[1,0,0] neg_hi:[1,0,0]
    v_pk_fma_f32 v[112:113], v[108:109], v[66:67], v[112:113]
    v_pk_fma_f32 v[120:121], v[116:117], v[66:67], v[120:121]
    v_pk_fma_f32 v[96:97], v[92:93], v[54:55], v[96:97]
    v_pk_mul_f32 v[106:107], v[110:111], v[66:67]
    v_cvt_pk_bf16_f32 v240, v110, v112
    v_pk_mul_f32 v[114:115], v[118:119], v[66:67]
    v_cvt_pk_bf16_f32 v241, v111, v113
    v_pk_mul_f32 v[98:99], v[50:51], v[62:63]
    v_cvt_pk_bf16_f32 v242, v118, v120
    v_pk_mul_f32 v[108:109], v[110:111], v[68:69]
    v_cvt_pk_bf16_f32 v243, v119, v121
    v_pk_mul_f32 v[116:117], v[118:119], v[68:69]
    v_pk_mul_f32 v[100:101], v[50:51], v[64:65]
    v_cvt_pk_bf16_f32 v244, v94, v96
    v_pk_fma_f32 v[106:107], v[112:113], v[68:69], v[106:107] neg_lo:[1,0,0] neg_hi:[1,0,0]
    v_cvt_pk_bf16_f32 v245, v95, v97
    v_pk_fma_f32 v[114:115], v[120:121], v[68:69], v[114:115] neg_lo:[1,0,0] neg_hi:[1,0,0]
    v_pk_fma_f32 v[98:99], v[52:53], v[64:65], v[98:99] neg_lo:[1,0,0] neg_hi:[1,0,0]
    v_pk_fma_f32 v[108:109], v[112:113], v[66:67], v[108:109]
    v_pk_fma_f32 v[116:117], v[120:121], v[66:67], v[116:117]
    v_pk_fma_f32 v[100:101], v[52:53], v[62:63], v[100:101]
    v_pk_mul_f32 v[110:111], v[106:107], v[66:67]
    v_cvt_pk_bf16_f32 v246, v106, v108
    v_pk_mul_f32 v[118:119], v[114:115], v[66:67]
    v_cvt_pk_bf16_f32 v247, v107, v109
    v_pk_mul_f32 v[102:103], v[98:99], v[62:63]
    v_cvt_pk_bf16_f32 v248, v114, v116
    v_pk_mul_f32 v[112:113], v[106:107], v[68:69]
    v_cvt_pk_bf16_f32 v249, v115, v117
    v_pk_mul_f32 v[120:121], v[114:115], v[68:69]
    v_pk_mul_f32 v[104:105], v[98:99], v[64:65]
    v_cvt_pk_bf16_f32 v250, v98, v100
    v_pk_fma_f32 v[110:111], v[108:109], v[68:69], v[110:111] neg_lo:[1,0,0] neg_hi:[1,0,0]
    v_cvt_pk_bf16_f32 v251, v99, v101
    v_pk_fma_f32 v[118:119], v[116:117], v[68:69], v[118:119] neg_lo:[1,0,0] neg_hi:[1,0,0]
    ds_write2st64_b64 v165, v[232:233], v[248:249] offset0:10 offset1:74
    v_pk_fma_f32 v[102:103], v[100:101], v[64:65], v[102:103] neg_lo:[1,0,0] neg_hi:[1,0,0]
    ds_write2st64_b64 v160, v[234:235], v[250:251] offset0:64 offset1:16
    v_pk_fma_f32 v[112:113], v[108:109], v[66:67], v[112:113]
    v_pk_fma_f32 v[120:121], v[116:117], v[66:67], v[120:121]
    v_pk_fma_f32 v[104:105], v[100:101], v[62:63], v[104:105]
    v_pk_mul_f32 v[106:107], v[110:111], v[66:67]
    v_cvt_pk_bf16_f32 v128, v110, v112
    v_pk_mul_f32 v[114:115], v[118:119], v[66:67]
    v_cvt_pk_bf16_f32 v129, v111, v113
    v_pk_mul_f32 v[98:99], v[102:103], v[62:63]
    v_cvt_pk_bf16_f32 v136, v118, v120
    v_pk_mul_f32 v[108:109], v[110:111], v[68:69]
    v_cvt_pk_bf16_f32 v137, v119, v121
    v_pk_mul_f32 v[116:117], v[118:119], v[68:69]
    ds_write2st64_b64 v166, v[238:239], v[128:129] offset0:12 offset1:76
    v_pk_mul_f32 v[100:101], v[102:103], v[64:65]
    v_cvt_pk_bf16_f32 v134, v102, v104
    v_pk_fma_f32 v[106:107], v[112:113], v[68:69], v[106:107] neg_lo:[1,0,0] neg_hi:[1,0,0]
    v_cvt_pk_bf16_f32 v135, v103, v105
    v_pk_fma_f32 v[114:115], v[120:121], v[68:69], v[114:115] neg_lo:[1,0,0] neg_hi:[1,0,0]
    ds_write2st64_b64 v167, v[244:245], v[136:137] offset0:14 offset1:78
    v_pk_fma_f32 v[98:99], v[104:105], v[64:65], v[98:99] neg_lo:[1,0,0] neg_hi:[1,0,0]
    ds_write2st64_b64 v164, v[246:247], v[134:135] offset0:72 offset1:24
    v_pk_fma_f32 v[108:109], v[112:113], v[66:67], v[108:109]
    v_pk_fma_f32 v[116:117], v[120:121], v[66:67], v[116:117]
    v_pk_fma_f32 v[100:101], v[104:105], v[62:63], v[100:101]
    s_cmp_lt_u32 s2, 128
    s_cbranch_scc1 F_nompub
    s_waitcnt vmcnt(0)
    v_readfirstlane_b32 s33, v151
    s_mov_b32 s35, 0
F_n1_l:
    s_cmp_lg_u32 s33, 0
    s_cbranch_scc1 F_n1_ok
    global_load_dword v151, v153, s[76:77] sc1
    s_add_u32 s35, s35, 1
    s_waitcnt vmcnt(0)
    v_readfirstlane_b32 s33, v151
    s_cmp_lt_u32 s35, 0x80000
    s_cbranch_scc1 F_n1_l
F_n1_ok:
    s_cmp_lg_u32 s6, 3
    s_cbranch_scc1 F_nompub
    s_mov_b64 exec, 1
    global_store_dword v150, v151, s[8:9] sc1
    s_mov_b64 exec, -1
F_nompub:
    v_pk_mul_f32 v[110:111], v[106:107], v[66:67]
    v_cvt_pk_bf16_f32 v138, v106, v108
    v_pk_mul_f32 v[118:119], v[114:115], v[66:67]
    v_cvt_pk_bf16_f32 v139, v107, v109
    v_pk_mul_f32 v[102:103], v[98:99], v[62:63]
    v_cvt_pk_bf16_f32 v140, v114, v116
    v_pk_mul_f32 v[70:71], v[82:83], v[62:63]
    v_cvt_pk_bf16_f32 v141, v115, v117
    v_pk_mul_f32 v[112:113], v[106:107], v[68:69]
    v_pk_mul_f32 v[120:121], v[114:115], v[68:69]
    v_cvt_pk_bf16_f32 v142, v98, v100
    v_pk_mul_f32 v[104:105], v[98:99], v[64:65]
    v_cvt_pk_bf16_f32 v143, v99, v101
    v_pk_mul_f32 v[72:73], v[82:83], v[64:65]
    ds_write2st64_b64 v161, v[236:237], v[140:141] offset0:66 offset1:82
    v_pk_fma_f32 v[110:111], v[108:109], v[68:69], v[110:111] neg_lo:[1,0,0] neg_hi:[1,0,0]
    v_pk_fma_f32 v[118:119], v[116:117], v[68:69], v[118:119] neg_lo:[1,0,0] neg_hi:[1,0,0]
    v_pk_fma_f32 v[102:103], v[100:101], v[64:65], v[102:103] neg_lo:[1,0,0] neg_hi:[1,0,0]
    v_pk_fma_f32 v[70:71], v[84:85], v[64:65], v[70:71] neg_lo:[1,0,0] neg_hi:[1,0,0]
    v_pk_fma_f32 v[112:113], v[108:109], v[66:67], v[112:113]
    v_pk_fma_f32 v[120:121], v[116:117], v[66:67], v[120:121]
    v_pk_fma_f32 v[104:105], v[100:101], v[62:63], v[104:105]
    v_pk_fma_f32 v[72:73], v[84:85], v[62:63], v[72:73]
    v_pk_mul_f32 v[106:107], v[110:111], v[66:67]
    v_cvt_pk_bf16_f32 v144, v110, v112
    v_pk_mul_f32 v[114:115], v[118:119], v[66:67]
    v_cvt_pk_bf16_f32 v145, v111, v113
    v_pk_mul_f32 v[98:99], v[102:103], v[62:63]
    v_cvt_pk_bf16_f32 v146, v118, v120
    v_pk_mul_f32 v[78:79], v[70:71], v[62:63]
    v_cvt_pk_bf16_f32 v147, v119, v121
    v_pk_mul_f32 v[108:109], v[110:111], v[68:69]
    ds_write2st64_b64 v162, v[240:241], v[144:145] offset0:68 offset1:84
    v_pk_mul_f32 v[116:117], v[118:119], v[68:69]
    v_cvt_pk_bf16_f32 v224, v102, v104
    v_pk_mul_f32 v[100:101], v[102:103], v[64:65]
    v_cvt_pk_bf16_f32 v225, v103, v105
    v_pk_mul_f32 v[80:81], v[70:71], v[64:65]
    ds_write2st64_b64 v163, v[242:243], v[146:147] offset0:70 offset1:86
    v_pk_fma_f32 v[106:107], v[112:113], v[68:69], v[106:107] neg_lo:[1,0,0] neg_hi:[1,0,0]
    v_cvt_pk_bf16_f32 v148, v70, v72
    v_pk_fma_f32 v[114:115], v[120:121], v[68:69], v[114:115] neg_lo:[1,0,0] neg_hi:[1,0,0]
    v_cvt_pk_bf16_f32 v149, v71, v73
    v_pk_fma_f32 v[98:99], v[104:105], v[64:65], v[98:99] neg_lo:[1,0,0] neg_hi:[1,0,0]
    ds_write2st64_b64 v160, v[138:139], v[224:225] offset0:80 offset1:32
    v_pk_fma_f32 v[78:79], v[72:73], v[64:65], v[78:79] neg_lo:[1,0,0] neg_hi:[1,0,0]
    v_pk_fma_f32 v[108:109], v[112:113], v[66:67], v[108:109]
    v_pk_fma_f32 v[116:117], v[120:121], v[66:67], v[116:117]
    v_pk_fma_f32 v[100:101], v[104:105], v[62:63], v[100:101]
    v_pk_fma_f32 v[80:81], v[72:73], v[62:63], v[80:81]
    v_pk_mul_f32 v[110:111], v[106:107], v[66:67]
    v_cvt_pk_bf16_f32 v226, v106, v108
    v_pk_mul_f32 v[118:119], v[114:115], v[66:67]
    v_cvt_pk_bf16_f32 v227, v107, v109
    v_pk_mul_f32 v[102:103], v[98:99], v[62:63]
    v_cvt_pk_bf16_f32 v130, v114, v116
    v_pk_mul_f32 v[70:71], v[78:79], v[62:63]
    v_cvt_pk_bf16_f32 v131, v115, v117
    v_pk_mul_f32 v[112:113], v[106:107], v[68:69]
    v_pk_mul_f32 v[120:121], v[114:115], v[68:69]
    v_cvt_pk_bf16_f32 v228, v98, v100
    v_pk_mul_f32 v[104:105], v[98:99], v[64:65]
    v_cvt_pk_bf16_f32 v229, v99, v101
    v_pk_mul_f32 v[72:73], v[78:79], v[64:65]
    v_pk_fma_f32 v[110:111], v[108:109], v[68:69], v[110:111] neg_lo:[1,0,0] neg_hi:[1,0,0]
    v_cvt_pk_bf16_f32 v132, v78, v80
    v_pk_fma_f32 v[118:119], v[116:117], v[68:69], v[118:119] neg_lo:[1,0,0] neg_hi:[1,0,0]
    v_cvt_pk_bf16_f32 v133, v79, v81
    v_pk_fma_f32 v[102:103], v[100:101], v[64:65], v[102:103] neg_lo:[1,0,0] neg_hi:[1,0,0]
    v_pk_fma_f32 v[70:71], v[80:81], v[64:65], v[70:71] neg_lo:[1,0,0] neg_hi:[1,0,0]
    ds_write2st64_b64 v165, v[130:131], v[132:133] offset0:90 offset1:26
    v_pk_fma_f32 v[112:113], v[108:109], v[66:67], v[112:113]
    v_pk_fma_f32 v[120:121], v[116:117], v[66:67], v[120:121]
    v_pk_fma_f32 v[104:105], v[100:101], v[62:63], v[104:105]
    v_pk_fma_f32 v[72:73], v[80:81], v[62:63], v[72:73]
    v_pk_mul_f32 v[106:107], v[110:111], v[66:67]
    v_cvt_pk_bf16_f32 v230, v110, v112
    v_pk_mul_f32 v[114:115], v[118:119], v[66:67]
    v_cvt_pk_bf16_f32 v231, v111, v113
    v_pk_mul_f32 v[98:99], v[102:103], v[62:63]
    v_cvt_pk_bf16_f32 v232, v118, v120
    v_pk_mul_f32 v[86:87], v[74:75], v[62:63]
    v_cvt_pk_bf16_f32 v233, v119, v121
    v_pk_mul_f32 v[108:109], v[110:111], v[68:69]
    ds_write2st64_b64 v166, v[142:143], v[230:231] offset0:28 offset1:92
    v_pk_mul_f32 v[116:117], v[118:119], v[68:69]
    v_cvt_pk_bf16_f32 v248, v102, v104
    v_pk_mul_f32 v[100:101], v[102:103], v[64:65]
    v_cvt_pk_bf16_f32 v249, v103, v105
    v_pk_mul_f32 v[88:89], v[74:75], v[64:65]
    v_pk_fma_f32 v[106:107], v[112:113], v[68:69], v[106:107] neg_lo:[1,0,0] neg_hi:[1,0,0]
    v_cvt_pk_bf16_f32 v234, v70, v72
    v_pk_fma_f32 v[114:115], v[120:121], v[68:69], v[114:115] neg_lo:[1,0,0] neg_hi:[1,0,0]
    v_cvt_pk_bf16_f32 v235, v71, v73
    v_pk_fma_f32 v[98:99], v[104:105], v[64:65], v[98:99] neg_lo:[1,0,0] neg_hi:[1,0,0]
    ds_write2st64_b64 v162, v[148:149], v[248:249] offset0:20 offset1:36
    v_pk_fma_f32 v[86:87], v[76:77], v[64:65], v[86:87] neg_lo:[1,0,0] neg_hi:[1,0,0]
    ds_write2st64_b64 v167, v[232:233], v[234:235] offset0:94 offset1:30
    v_pk_fma_f32 v[108:109], v[112:113], v[66:67], v[108:109]
    v_pk_fma_f32 v[116:117], v[120:121], v[66:67], v[116:117]
    v_pk_fma_f32 v[100:101], v[104:105], v[62:63], v[100:101]
    v_pk_fma_f32 v[88:89], v[76:77], v[62:63], v[88:89]
    v_pk_mul_f32 v[110:111], v[106:107], v[66:67]
    v_cvt_pk_bf16_f32 v250, v106, v108
    v_pk_mul_f32 v[118:119], v[114:115], v[66:67]
    v_cvt_pk_bf16_f32 v251, v107, v109
    v_pk_mul_f32 v[102:103], v[98:99], v[62:63]
    v_cvt_pk_bf16_f32 v238, v114, v116
    v_pk_mul_f32 v[94:95], v[90:91], v[62:63]
    v_cvt_pk_bf16_f32 v239, v115, v117
    v_pk_mul_f32 v[112:113], v[106:107], v[68:69]
    v_pk_mul_f32 v[120:121], v[114:115], v[68:69]
    v_cvt_pk_bf16_f32 v128, v98, v100
    v_pk_mul_f32 v[104:105], v[98:99], v[64:65]
    v_cvt_pk_bf16_f32 v129, v99, v101
    v_pk_mul_f32 v[96:97], v[90:91], v[64:65]
    ds_write2st64_b64 v161, v[228:229], v[238:239] offset0:34 offset1:98
    v_pk_fma_f32 v[110:111], v[108:109], v[68:69], v[110:111] neg_lo:[1,0,0] neg_hi:[1,0,0]
    v_cvt_pk_bf16_f32 v244, v86, v88
    v_pk_fma_f32 v[118:119], v[116:117], v[68:69], v[118:119] neg_lo:[1,0,0] neg_hi:[1,0,0]
    v_cvt_pk_bf16_f32 v245, v87, v89
    v_pk_fma_f32 v[102:103], v[100:101], v[64:65], v[102:103] neg_lo:[1,0,0] neg_hi:[1,0,0]
    v_pk_fma_f32 v[94:95], v[92:93], v[64:65], v[94:95] neg_lo:[1,0,0] neg_hi:[1,0,0]
    v_pk_fma_f32 v[112:113], v[108:109], v[66:67], v[112:113]
    v_pk_fma_f32 v[120:121], v[116:117], v[66:67], v[120:121]
    v_pk_fma_f32 v[104:105], v[100:101], v[62:63], v[104:105]
    v_pk_fma_f32 v[96:97], v[92:93], v[62:63], v[96:97]
    v_pk_mul_f32 v[106:107], v[110:111], v[66:67]
    v_cvt_pk_bf16_f32 v136, v110, v112
    v_pk_mul_f32 v[108:109], v[110:111], v[68:69]
    v_cvt_pk_bf16_f32 v137, v111, v113
    v_pk_fma_f32 v[106:107], v[112:113], v[68:69], v[106:107] neg_lo:[1,0,0] neg_hi:[1,0,0]
    v_cvt_pk_bf16_f32 v246, v118, v120
    v_pk_fma_f32 v[108:109], v[112:113], v[66:67], v[108:109]
    v_cvt_pk_bf16_f32 v247, v119, v121
    v_cvt_pk_bf16_f32 v134, v102, v104
    v_cvt_pk_bf16_f32 v135, v103, v105
    ds_write2st64_b64 v163, v[128:129], v[246:247] offset0:38 offset1:102
    v_cvt_pk_bf16_f32 v236, v94, v96
    v_cvt_pk_bf16_f32 v237, v95, v97
    ds_write2st64_b64 v164, v[226:227], v[134:135] offset0:88 offset1:40
    v_cvt_pk_bf16_f32 v140, v106, v108
    v_cvt_pk_bf16_f32 v141, v107, v109
    ds_write_b64 v160, v[250:251] offset:49152
    ds_write_b64 v161, v[244:245] offset:9216
    ds_write_b64 v162, v[136:137] offset:51200
    ds_write_b64 v163, v[236:237] offset:11264
    ds_write_b64 v164, v[140:141] offset:53248
    v_lshrrev_b32 v4, 1, v0
    v_and_b32 v5, 1, v0
    v_lshlrev_b32 v4, 6, v4
    v_lshl_add_u32 v4, v5, 4, v4
    s_mul_i32 s3, s2, 8320
    v_add_u32 v4, s3, v4
    v_lshlrev_b32 v5, 5, v0
    v_add_u32 v5, 2097152, v5
    s_lshl_b32 s3, s2, 4
    s_add_u32 s3, s3, 2428416
    v_mov_b32 v29, s3
    s_waitcnt lgkmcnt(0)
    s_barrier
    ds_read_b128 v[64:67], v216 offset:0
    ds_read_b128 v[68:71], v220 offset:0
    ds_read_b128 v[72:75], v220 offset:16384
    ds_read_b128 v[76:79], v217 offset:0
    ds_read_b128 v[80:83], v221 offset:0
    ds_read_b128 v[84:87], v221 offset:16384
    ds_read_b128 v[88:91], v218 offset:0
    ds_read_b128 v[92:95], v222 offset:0
    ds_read_b128 v[96:99], v222 offset:16384
    ds_read_b128 v[100:103], v219 offset:0
    ds_read_b128 v[104:107], v223 offset:0
    ds_read_b128 v[108:111], v223 offset:16384
    s_waitcnt lgkmcnt(9)
    v_mfma_f32_16x16x32_bf16 v[8:11], v[64:67], v[68:71], 0
    v_mfma_f32_16x16x32_bf16 v[12:15], v[64:67], v[72:75], 0
    ds_read_b128 v[112:115], v216 offset:256
    ds_read_b128 v[116:119], v220 offset:256
    ds_read_b128 v[120:123], v220 offset:16640
    s_waitcnt lgkmcnt(9)
    v_mfma_f32_16x16x32_bf16 v[8:11], v[76:79], v[80:83], v[8:11]
    v_mfma_f32_16x16x32_bf16 v[12:15], v[76:79], v[84:87], v[12:15]
    ds_read_b128 v[64:67], v217 offset:256
    ds_read_b128 v[68:71], v221 offset:256
    ds_read_b128 v[72:75], v221 offset:16640
    s_waitcnt lgkmcnt(9)
    v_mfma_f32_16x16x32_bf16 v[8:11], v[88:91], v[92:95], v[8:11]
    v_mfma_f32_16x16x32_bf16 v[12:15], v[88:91], v[96:99], v[12:15]
    ds_read_b128 v[76:79], v218 offset:256
    ds_read_b128 v[80:83], v222 offset:256
    ds_read_b128 v[84:87], v222 offset:16640
    s_waitcnt lgkmcnt(9)
    v_mfma_f32_16x16x32_bf16 v[8:11], v[100:103], v[104:107], v[8:11]
    v_mfma_f32_16x16x32_bf16 v[12:15], v[100:103], v[108:111], v[12:15]
    ds_read_b128 v[88:91], v219 offset:256
    ds_read_b128 v[92:95], v223 offset:256
    ds_read_b128 v[96:99], v223 offset:16640
    s_waitcnt lgkmcnt(9)
    v_mfma_f32_16x16x32_bf16 v[8:11], v[112:115], v[116:119], v[8:11]
    v_mfma_f32_16x16x32_bf16 v[12:15], v[112:115], v[120:123], v[12:15]
    ds_read_b128 v[100:103], v216 offset:512
    ds_read_b128 v[104:107], v220 offset:512
    ds_read_b128 v[108:111], v220 offset:16896
    s_waitcnt lgkmcnt(9)
    v_mfma_f32_16x16x32_bf16 v[8:11], v[64:67], v[68:71], v[8:11]
    v_mfma_f32_16x16x32_bf16 v[12:15], v[64:67], v[72:75], v[12:15]
    ds_read_b128 v[112:115], v217 offset:512
    ds_read_b128 v[116:119], v221 offset:512
    ds_read_b128 v[120:123], v221 offset:16896
    s_waitcnt lgkmcnt(9)
    v_mfma_f32_16x16x32_bf16 v[8:11], v[76:79], v[80:83], v[8:11]
    v_mfma_f32_16x16x32_bf16 v[12:15], v[76:79], v[84:87], v[12:15]
    ds_read_b128 v[64:67], v218 offset:512
    ds_read_b128 v[68:71], v222 offset:512
    ds_read_b128 v[72:75], v222 offset:16896
    v_min_u32 v20, 211, v0
    v_lshlrev_b32 v20, 6, v20
    v_add_u32 v20, 2293760, v20
    global_load_dword v24, v20, s[8:9] sc1
    s_waitcnt lgkmcnt(9)
    v_mfma_f32_16x16x32_bf16 v[8:11], v[88:91], v[92:95], v[8:11]
    v_mfma_f32_16x16x32_bf16 v[12:15], v[88:91], v[96:99], v[12:15]
    ds_read_b128 v[76:79], v219 offset:512
    ds_read_b128 v[80:83], v223 offset:512
    ds_read_b128 v[84:87], v223 offset:16896
    s_waitcnt lgkmcnt(9)
    v_mfma_f32_16x16x32_bf16 v[8:11], v[100:103], v[104:107], v[8:11]
    v_mfma_f32_16x16x32_bf16 v[12:15], v[100:103], v[108:111], v[12:15]
    ds_read_b128 v[88:91], v216 offset:768
    ds_read_b128 v[92:95], v220 offset:768
    ds_read_b128 v[96:99], v220 offset:17152
    s_waitcnt lgkmcnt(9)
    v_mfma_f32_16x16x32_bf16 v[8:11], v[112:115], v[116:119], v[8:11]
    v_mfma_f32_16x16x32_bf16 v[12:15], v[112:115], v[120:123], v[12:15]
    ds_read_b128 v[100:103], v217 offset:768
    ds_read_b128 v[104:107], v221 offset:768
    ds_read_b128 v[108:111], v221 offset:17152
    s_waitcnt lgkmcnt(9)
    v_mfma_f32_16x16x32_bf16 v[8:11], v[64:67], v[68:71], v[8:11]
    v_mfma_f32_16x16x32_bf16 v[12:15], v[64:67], v[72:75], v[12:15]
    ds_read_b128 v[112:115], v218 offset:768
    ds_read_b128 v[116:119], v222 offset:768
    ds_read_b128 v[120:123], v222 offset:17152
    s_waitcnt lgkmcnt(9)
    v_mfma_f32_16x16x32_bf16 v[8:11], v[76:79], v[80:83], v[8:11]
    v_mfma_f32_16x16x32_bf16 v[12:15], v[76:79], v[84:87], v[12:15]
    ds_read_b128 v[64:67], v219 offset:768
    ds_read_b128 v[68:71], v223 offset:768
    ds_read_b128 v[72:75], v223 offset:17152
    s_waitcnt lgkmcnt(9)
    v_mfma_f32_16x16x32_bf16 v[8:11], v[88:91], v[92:95], v[8:11]
    v_mfma_f32_16x16x32_bf16 v[12:15], v[88:91], v[96:99], v[12:15]
    s_waitcnt lgkmcnt(6)
    v_mfma_f32_16x16x32_bf16 v[8:11], v[100:103], v[104:107], v[8:11]
    v_mfma_f32_16x16x32_bf16 v[12:15], v[100:103], v[108:111], v[12:15]
    s_waitcnt lgkmcnt(3)
    v_mfma_f32_16x16x32_bf16 v[8:11], v[112:115], v[116:119], v[8:11]
    v_mfma_f32_16x16x32_bf16 v[12:15], v[112:115], v[120:123], v[12:15]
    s_waitcnt lgkmcnt(0)
    v_mfma_f32_16x16x32_bf16 v[8:11], v[64:67], v[68:71], v[8:11]
    v_mfma_f32_16x16x32_bf16 v[12:15], v[64:67], v[72:75], v[12:15]
    v_lshlrev_b32 v52, 4, v0
    v_add_u32 v53, 137408, v52
    v_add_u32 v52, 128736, v52
    v_mov_b32 v48, 0
    v_mov_b32 v49, 0
    v_lshlrev_b32 v50, 3, v0
    v_add_u32 v50, 128256, v50
    v_cvt_pk_bf16_f32 v8, v8, v9
    v_cvt_pk_bf16_f32 v10, v10, v11
    v_cvt_pk_bf16_f32 v12, v12, v13
    v_cvt_pk_bf16_f32 v14, v14, v15
    ds_write_b16 v40, v8
    ds_write_b16_d16_hi v41, v8
    ds_write_b16 v42, v10
    ds_write_b16_d16_hi v43, v10
    ds_write_b16 v44, v12
    ds_write_b16_d16_hi v45, v12
    ds_write_b16 v46, v14
    ds_write_b16_d16_hi v47, v14
    v_cmp_gt_u32 vcc, 60, v0
    s_nop 0
    s_and_saveexec_b64 s[22:23], vcc
    ds_write_b64 v50, v[48:49]
    ds_write_b64 v50, v[48:49] offset:4576
    s_mov_b64 exec, s[22:23]
    s_waitcnt vmcnt(0)
    s_mov_b32 s35, 0
F_pollA:
    v_cmp_ne_u32 vcc, s33, v24
    s_add_u32 s35, s35, 1
    s_nop 3
    s_cbranch_vccz F_pollA_done
    s_sleep 2
    global_load_dword v24, v20, s[8:9] sc1
    s_cmp_lt_u32 s35, 0x100000
    s_waitcnt vmcnt(0)
    s_cbranch_scc1 F_pollA
F_pollA_done:
    s_waitcnt lgkmcnt(0)
    s_barrier
    global_load_dwordx4 v[16:19], v4, s[8:9]
    global_load_dwordx4 v[20:23], v4, s[8:9] offset:32
    global_load_dwordx4 v[192:195], v5, s[8:9]
    global_load_dwordx4 v[196:199], v5, s[8:9] offset:16
    global_load_dwordx4 v[200:203], v29, s[8:9] offset:-3584
    global_load_dwordx4 v[204:207], v29, s[8:9]
    global_load_dwordx4 v[208:211], v29, s[8:9] offset:3584
    global_load_dword v253, v252, s[8:9] sc1
    ds_read_u16 v128, v30 offset:0
    ds_read_u16 v129, v31 offset:0
    ds_read_u16 v130, v32 offset:0
    ds_read_u16 v131, v33 offset:0
    ds_read_u16 v132, v34 offset:0
    ds_read_u16 v133, v35 offset:0
    ds_read_u16 v134, v36 offset:0
    ds_read_u16 v135, v37 offset:0
    ds_read_u16 v136, v38 offset:0
    ds_read_u16 v144, v30 offset:1536
    ds_read_u16 v145, v31 offset:1536
    ds_read_u16 v146, v32 offset:1536
    ds_read_u16 v147, v33 offset:1536
    ds_read_u16 v148, v34 offset:1536
    ds_read_u16 v149, v35 offset:1536
    ds_read_u16 v150, v36 offset:1536
    ds_read_u16 v151, v37 offset:1536
    ds_read_u16 v152, v38 offset:1536
    v_lshlrev_b32 v28, 4, v0
    v_add_u32 v28, 111616, v28
    s_and_b32 s48, s6, 1
    v_and_b32 v40, 15, v0
    v_bfe_u32 v41, v0, 4, 2
    s_mul_i32 s49, s38, 4576
    s_lshl_b32 s50, s48, 8
    s_add_u32 s49, s49, s50
    s_add_u32 s49, s49, 128256
    v_lshlrev_b32 v42, 5, v40
    v_lshl_add_u32 v42, v41, 4, v42
    v_add_u32 v42, s49, v42
    v_lshlrev_b32 v43, 3, v41
    v_sub_u32 v43, v43, v40
    v_add_u32 v43, 1807, v43
    v_and_b32 v44, 1, v43
    v_and_b32 v43, -2, v43
    v_lshlrev_b32 v43, 1, v43
    v_mul_u32_u24 v44, 4160, v44
    s_mul_i32 s49, s38, 8320
    s_add_u32 s49, s49, s50
    s_add_u32 s49, s49, 111104
    s_waitcnt lgkmcnt(9)
    v_lshl_or_b32 v160, v129, 16, v128
    v_lshl_or_b32 v161, v131, 16, v130
    v_lshl_or_b32 v162, v133, 16, v132
    v_lshl_or_b32 v163, v135, 16, v134
    ds_write_b128 v28, v[160:163] offset:0
    v_lshl_or_b32 v164, v130, 16, v129
    v_lshl_or_b32 v165, v132, 16, v131
    v_lshl_or_b32 v166, v134, 16, v133
    v_lshl_or_b32 v167, v136, 16, v135
    ds_write_b128 v28, v[164:167] offset:4160
    s_waitcnt lgkmcnt(2)
    v_lshl_or_b32 v168, v145, 16, v144
    v_lshl_or_b32 v169, v147, 16, v146
    v_lshl_or_b32 v170, v149, 16, v148
    v_lshl_or_b32 v171, v151, 16, v150
    ds_write_b128 v28, v[168:171] offset:8320
    v_lshl_or_b32 v172, v146, 16, v145
    v_lshl_or_b32 v173, v148, 16, v147
    v_lshl_or_b32 v174, v150, 16, v149
    v_lshl_or_b32 v175, v152, 16, v151
    ds_write_b128 v28, v[172:175] offset:12480
    s_waitcnt vmcnt(0)
    s_mov_b32 s35, 0
F_pollC:
    v_cmp_ne_u32 vcc, s33, v253
    s_add_u32 s35, s35, 1
    s_nop 3
    s_cbranch_vccz F_pollC_done
    s_sleep 2
    global_load_dword v253, v252, s[8:9] sc1
    s_cmp_lt_u32 s35, 0x100000
    s_waitcnt vmcnt(0)
    s_cbranch_scc1 F_pollC
F_pollC_done:
    buffer_load_dwordx4 a[0:3], v1, s[12:15], s18 offen offset:0
    buffer_load_dwordx4 a[4:7], v1, s[12:15], s18 offen offset:1024
    v_add_f32 v200, v200, v201
    v_add_f32 v201, v202, v203
    v_add_f32 v204, v204, v205
    v_add_f32 v205, v206, v207
    v_add_f32 v208, v208, v209
    v_add_f32 v209, v210, v211
    v_cvt_pk_bf16_f32 v204, v204, v205
    v_cvt_pk_bf16_f32 v200, v200, v201
    v_cvt_pk_bf16_f32 v208, v208, v209
    v_lshlrev_b32 v202, 16, v204
    v_and_b32 v203, 0xffff0000, v204
    v_add_f32 v202, 1.0, v202
    v_add_f32 v203, 1.0, v203
    v_and_b32 v64, 0xffff0000, v192
    v_and_b32 v65, 0xffff0000, v193
    v_and_b32 v66, 0xffff0000, v194
    v_and_b32 v67, 0xffff0000, v195
    v_and_b32 v68, 0xffff0000, v196
    v_and_b32 v69, 0xffff0000, v197
    v_and_b32 v70, 0xffff0000, v198
    v_and_b32 v71, 0xffff0000, v199
    v_readfirstlane_b32 s36, v208
    v_cvt_pk_bf16_f32 v204, 0, v202
    v_cvt_pk_bf16_f32 v206, 0, v203
    v_lshlrev_b32 v205, 16, v200
    v_and_b32 v207, 0xffff0000, v200
    buffer_load_dwordx4 a[8:11], v1, s[12:15], s18 offen offset:2048
    v_rcp_f32 v64, v64
    v_rcp_f32 v65, v65
    v_rcp_f32 v66, v66
    v_rcp_f32 v67, v67
    v_rcp_f32 v68, v68
    v_rcp_f32 v69, v69
    v_rcp_f32 v70, v70
    v_rcp_f32 v71, v71
    buffer_load_dwordx4 a[12:15], v1, s[12:15], s18 offen offset:3072
    v_lshlrev_b32 v72, 16, v192
    v_lshlrev_b32 v73, 16, v193
    v_lshlrev_b32 v74, 16, v194
    v_lshlrev_b32 v75, 16, v195
    v_lshlrev_b32 v76, 16, v196
    v_lshlrev_b32 v77, 16, v197
    v_lshlrev_b32 v78, 16, v198
    v_lshlrev_b32 v79, 16, v199
    v_lshlrev_b32 v80, 16, v16
    v_and_b32 v81, 0xffff0000, v16
    v_lshlrev_b32 v82, 16, v17
    v_and_b32 v83, 0xffff0000, v17
    v_lshlrev_b32 v84, 16, v18
    v_and_b32 v85, 0xffff0000, v18
    v_lshlrev_b32 v86, 16, v19
    v_and_b32 v87, 0xffff0000, v19
    ds_write_b128 v53, v[16:19] offset:0
    v_lshlrev_b32 v88, 16, v20
    v_and_b32 v89, 0xffff0000, v20
    v_lshlrev_b32 v90, 16, v21
    v_and_b32 v91, 0xffff0000, v21
    v_lshlrev_b32 v92, 16, v22
    v_and_b32 v93, 0xffff0000, v22
    v_lshlrev_b32 v94, 16, v23
    v_and_b32 v95, 0xffff0000, v23
    ds_write_b128 v53, v[20:23] offset:4096
    v_pk_add_f32 v[80:81], v[80:81], v[72:73] neg_lo:[0,1] neg_hi:[0,1]
    v_pk_add_f32 v[82:83], v[82:83], v[74:75] neg_lo:[0,1] neg_hi:[0,1]
    v_pk_add_f32 v[84:85], v[84:85], v[76:77] neg_lo:[0,1] neg_hi:[0,1]
    v_pk_add_f32 v[86:87], v[86:87], v[78:79] neg_lo:[0,1] neg_hi:[0,1]
    v_pk_add_f32 v[88:89], v[88:89], v[72:73] neg_lo:[0,1] neg_hi:[0,1]
    v_pk_add_f32 v[90:91], v[90:91], v[74:75] neg_lo:[0,1] neg_hi:[0,1]
    v_pk_add_f32 v[92:93], v[92:93], v[76:77] neg_lo:[0,1] neg_hi:[0,1]
    v_pk_add_f32 v[94:95], v[94:95], v[78:79] neg_lo:[0,1] neg_hi:[0,1]
    s_add_u32 s18, s18, 4096
    buffer_load_dwordx4 a[16:19], v1, s[12:15], s18 offen offset:0
    v_pk_mul_f32 v[80:81], v[80:81], v[64:65]
    v_pk_mul_f32 v[82:83], v[82:83], v[66:67]
    v_pk_mul_f32 v[84:85], v[84:85], v[68:69]
    v_pk_mul_f32 v[86:87], v[86:87], v[70:71]
    v_pk_mul_f32 v[88:89], v[88:89], v[64:65]
    v_pk_mul_f32 v[90:91], v[90:91], v[66:67]
    v_pk_mul_f32 v[92:93], v[92:93], v[68:69]
    v_pk_mul_f32 v[94:95], v[94:95], v[70:71]
    v_pk_fma_f32 v[80:81], v[80:81], v[204:205], v[204:205] op_sel:[0,0,1] op_sel_hi:[1,0,1]
    v_pk_fma_f32 v[82:83], v[82:83], v[204:205], v[204:205] op_sel:[0,0,1] op_sel_hi:[1,0,1]
    v_pk_fma_f32 v[84:85], v[84:85], v[204:205], v[204:205] op_sel:[0,0,1] op_sel_hi:[1,0,1]
    v_pk_fma_f32 v[86:87], v[86:87], v[204:205], v[204:205] op_sel:[0,0,1] op_sel_hi:[1,0,1]
    v_pk_fma_f32 v[88:89], v[88:89], v[206:207], v[206:207] op_sel:[0,0,1] op_sel_hi:[1,0,1]
    v_pk_fma_f32 v[90:91], v[90:91], v[206:207], v[206:207] op_sel:[0,0,1] op_sel_hi:[1,0,1]
    v_pk_fma_f32 v[92:93], v[92:93], v[206:207], v[206:207] op_sel:[0,0,1] op_sel_hi:[1,0,1]
    v_pk_fma_f32 v[94:95], v[94:95], v[206:207], v[206:207] op_sel:[0,0,1] op_sel_hi:[1,0,1]
    v_cvt_pk_bf16_f32 v96, v80, v81
    v_cvt_pk_bf16_f32 v97, v82, v83
    v_cvt_pk_bf16_f32 v98, v84, v85
    v_cvt_pk_bf16_f32 v99, v86, v87
    ds_write_b128 v52, v[96:99] offset:0
    v_cvt_pk_bf16_f32 v100, v88, v89
    v_cvt_pk_bf16_f32 v101, v90, v91
    v_cvt_pk_bf16_f32 v102, v92, v93
    v_cvt_pk_bf16_f32 v103, v94, v95
    ds_write_b128 v52, v[100:103] offset:4576
    s_lshl_b32 s36, s36, s67
    s_and_b32 s36, s36, 0xffff0000
    v_cmp_gt_u32 vcc, 4, v0
    s_nop 0
    s_and_saveexec_b64 s[22:23], vcc
    v_lshlrev_b32 v28, 3, v0
    v_add_u32 v28, 115712, v28
    ds_write_b64 v28, v[48:49]
    ds_write_b64 v28, v[48:49] offset:4160
    ds_write_b64 v28, v[48:49] offset:8320
    ds_write_b64 v28, v[48:49] offset:12480
    s_mov_b64 exec, s[22:23]
    v_add3_u32 v43, v43, v44, s49
    v_subrev_u32 v44, 1024, v43
    v_subrev_u32 v45, 2048, v43
    v_subrev_u32 v46, 3072, v43
    s_waitcnt lgkmcnt(0)
    s_barrier
    ds_read_b128 v[64:67], v42 offset:0
    ds_read2_b32 v[96:97], v43 offset0:128 offset1:129
    ds_read2_b32 v[98:99], v43 offset0:130 offset1:131
    ds_read_b128 v[68:71], v42 offset:512
    ds_read2_b32 v[100:101], v43 offset0:0 offset1:1
    ds_read2_b32 v[102:103], v43 offset0:2 offset1:3
    ds_read_b128 v[72:75], v42 offset:1024
    ds_read2_b32 v[104:105], v44 offset0:128 offset1:129
    ds_read2_b32 v[106:107], v44 offset0:130 offset1:131
    ds_read_b128 v[76:79], v42 offset:1536
    ds_read2_b32 v[108:109], v44 offset0:0 offset1:1
    ds_read2_b32 v[110:111], v44 offset0:2 offset1:3
    ds_read_b128 v[80:83], v42 offset:2048
    ds_read2_b32 v[112:113], v45 offset0:128 offset1:129
    ds_read2_b32 v[114:115], v45 offset0:130 offset1:131
    ds_read_b128 v[84:87], v42 offset:2560
    ds_read2_b32 v[116:117], v45 offset0:0 offset1:1
    ds_read2_b32 v[118:119], v45 offset0:2 offset1:3
    ds_read_b128 v[88:91], v42 offset:3072
    ds_read2_b32 v[120:121], v46 offset0:128 offset1:129
    ds_read2_b32 v[122:123], v46 offset0:130 offset1:131
    ds_read_b128 v[92:95], v42 offset:3584
    ds_read2_b32 v[124:125], v46 offset0:0 offset1:1
    ds_read2_b32 v[126:127], v46 offset0:2 offset1:3
    s_waitcnt lgkmcnt(15)
    v_mfma_f32_16x16x32_bf16 v[192:195], v[96:99], v[64:67], 0
    v_mfma_f32_16x16x32_bf16 v[196:199], v[96:99], v[68:71], 0
    v_mfma_f32_16x16x32_bf16 v[196:199], v[100:103], v[64:67], v[196:199]
    v_mfma_f32_16x16x32_bf16 v[200:203], v[100:103], v[68:71], 0
    buffer_load_dwordx4 a[20:23], v1, s[12:15], s18 offen offset:1024
    v_mfma_f32_16x16x32_bf16 v[200:203], v[96:99], v[72:75], v[200:203]
    v_mfma_f32_16x16x32_bf16 v[204:207], v[100:103], v[72:75], 0
    v_mfma_f32_16x16x32_bf16 v[200:203], v[104:107], v[64:67], v[200:203]
    ds_read_b128 v[128:131], v42 offset:64
    v_mfma_f32_16x16x32_bf16 v[204:207], v[104:107], v[68:71], v[204:207]
    ds_read2_b32 v[160:161], v43 offset0:144 offset1:145
    buffer_load_dwordx4 a[24:27], v1, s[12:15], s18 offen offset:2048
    v_mfma_f32_16x16x32_bf16 v[208:211], v[104:107], v[72:75], 0
    ds_read2_b32 v[162:163], v43 offset0:146 offset1:147
    s_waitcnt lgkmcnt(15)
    v_mfma_f32_16x16x32_bf16 v[204:207], v[96:99], v[76:79], v[204:207]
    ds_read_b128 v[132:135], v42 offset:576
    v_mfma_f32_16x16x32_bf16 v[208:211], v[100:103], v[76:79], v[208:211]
    ds_read2_b32 v[164:165], v43 offset0:16 offset1:17
    v_mfma_f32_16x16x32_bf16 v[212:215], v[104:107], v[76:79], 0
    ds_read2_b32 v[166:167], v43 offset0:18 offset1:19
    buffer_load_dwordx4 a[28:31], v1, s[12:15], s18 offen offset:3072
    v_mfma_f32_16x16x32_bf16 v[204:207], v[108:111], v[64:67], v[204:207]
    ds_read_b128 v[136:139], v42 offset:1088
    v_mfma_f32_16x16x32_bf16 v[208:211], v[108:111], v[68:71], v[208:211]
    ds_read2_b32 v[168:169], v44 offset0:144 offset1:145
    v_mfma_f32_16x16x32_bf16 v[212:215], v[108:111], v[72:75], v[212:215]
    ds_read2_b32 v[170:171], v44 offset0:146 offset1:147
    v_mfma_f32_16x16x32_bf16 v[216:219], v[108:111], v[76:79], 0
    ds_read_b128 v[140:143], v42 offset:1600
    s_add_u32 s18, s18, 4096
    buffer_load_dwordx4 a[32:35], v1, s[12:15], s18 offen offset:0
    s_waitcnt lgkmcnt(15)
    v_mfma_f32_16x16x32_bf16 v[208:211], v[96:99], v[80:83], v[208:211]
    ds_read2_b32 v[172:173], v44 offset0:16 offset1:17
    v_mfma_f32_16x16x32_bf16 v[212:215], v[100:103], v[80:83], v[212:215]
    ds_read2_b32 v[174:175], v44 offset0:18 offset1:19
    v_mfma_f32_16x16x32_bf16 v[216:219], v[104:107], v[80:83], v[216:219]
    ds_read_b128 v[144:147], v42 offset:2112
    v_mfma_f32_16x16x32_bf16 v[220:223], v[108:111], v[80:83], 0
    ds_read2_b32 v[176:177], v45 offset0:144 offset1:145
    buffer_load_dwordx4 a[36:39], v1, s[12:15], s18 offen offset:1024
    v_mfma_f32_16x16x32_bf16 v[208:211], v[112:115], v[64:67], v[208:211]
    ds_read2_b32 v[178:179], v45 offset0:146 offset1:147
    v_mfma_f32_16x16x32_bf16 v[212:215], v[112:115], v[68:71], v[212:215]
    ds_read_b128 v[148:151], v42 offset:2624
    v_mfma_f32_16x16x32_bf16 v[216:219], v[112:115], v[72:75], v[216:219]
    ds_read2_b32 v[180:181], v45 offset0:16 offset1:17
    v_mfma_f32_16x16x32_bf16 v[220:223], v[112:115], v[76:79], v[220:223]
    ds_read2_b32 v[182:183], v45 offset0:18 offset1:19
    buffer_load_dwordx4 a[40:43], v1, s[12:15], s18 offen offset:2048
    v_mfma_f32_16x16x32_bf16 v[212:215], v[96:99], v[84:87], v[212:215]
    ds_read_b128 v[152:155], v42 offset:3136
    v_mfma_f32_16x16x32_bf16 v[216:219], v[100:103], v[84:87], v[216:219]
    ds_read2_b32 v[184:185], v46 offset0:144 offset1:145
    v_mfma_f32_16x16x32_bf16 v[220:223], v[104:107], v[84:87], v[220:223]
    ds_read2_b32 v[186:187], v46 offset0:146 offset1:147
    v_mfma_f32_16x16x32_bf16 v[212:215], v[116:119], v[64:67], v[212:215]
    ds_read_b128 v[156:159], v42 offset:3648
    buffer_load_dwordx4 a[44:47], v1, s[12:15], s18 offen offset:3072
    v_mfma_f32_16x16x32_bf16 v[216:219], v[116:119], v[68:71], v[216:219]
    ds_read2_b32 v[188:189], v46 offset0:16 offset1:17
    v_mfma_f32_16x16x32_bf16 v[220:223], v[116:119], v[72:75], v[220:223]
    ds_read2_b32 v[190:191], v46 offset0:18 offset1:19
    v_mfma_f32_16x16x32_bf16 v[216:219], v[96:99], v[88:91], v[216:219]
    v_mfma_f32_16x16x32_bf16 v[220:223], v[100:103], v[88:91], v[220:223]
    s_add_u32 s18, s18, 4096
    buffer_load_dwordx4 a[48:51], v1, s[12:15], s18 offen offset:0
    s_waitcnt lgkmcnt(15)
    v_mfma_f32_16x16x32_bf16 v[216:219], v[120:123], v[64:67], v[216:219]
    v_mfma_f32_16x16x32_bf16 v[220:223], v[120:123], v[68:71], v[220:223]
    v_mfma_f32_16x16x32_bf16 v[220:223], v[96:99], v[92:95], v[220:223]
    v_mfma_f32_16x16x32_bf16 v[220:223], v[124:127], v[64:67], v[220:223]
    buffer_load_dwordx4 a[52:55], v1, s[12:15], s18 offen offset:1024
    v_mfma_f32_16x16x32_bf16 v[192:195], v[160:163], v[128:131], v[192:195]
    v_mfma_f32_16x16x32_bf16 v[196:199], v[160:163], v[132:135], v[196:199]
    v_mfma_f32_16x16x32_bf16 v[196:199], v[164:167], v[128:131], v[196:199]
    v_mfma_f32_16x16x32_bf16 v[200:203], v[164:167], v[132:135], v[200:203]
    buffer_load_dwordx4 a[56:59], v1, s[12:15], s18 offen offset:2048
    v_mfma_f32_16x16x32_bf16 v[200:203], v[160:163], v[136:139], v[200:203]
    v_mfma_f32_16x16x32_bf16 v[204:207], v[164:167], v[136:139], v[204:207]
    v_mfma_f32_16x16x32_bf16 v[200:203], v[168:171], v[128:131], v[200:203]
    ds_read_b128 v[64:67], v42 offset:128
    v_mfma_f32_16x16x32_bf16 v[204:207], v[168:171], v[132:135], v[204:207]
    ds_read2_b32 v[96:97], v43 offset0:160 offset1:161
    buffer_load_dwordx4 a[60:63], v1, s[12:15], s18 offen offset:3072
    v_mfma_f32_16x16x32_bf16 v[208:211], v[168:171], v[136:139], v[208:211]
    ds_read2_b32 v[98:99], v43 offset0:162 offset1:163
    s_waitcnt lgkmcnt(15)
    v_mfma_f32_16x16x32_bf16 v[204:207], v[160:163], v[140:143], v[204:207]
    ds_read_b128 v[68:71], v42 offset:640
    v_mfma_f32_16x16x32_bf16 v[208:211], v[164:167], v[140:143], v[208:211]
    ds_read2_b32 v[100:101], v43 offset0:32 offset1:33
    v_mfma_f32_16x16x32_bf16 v[212:215], v[168:171], v[140:143], v[212:215]
    ds_read2_b32 v[102:103], v43 offset0:34 offset1:35
    s_add_u32 s18, s18, 4096
    buffer_load_dwordx4 a[64:67], v1, s[12:15], s18 offen offset:0
    v_mfma_f32_16x16x32_bf16 v[204:207], v[172:175], v[128:131], v[204:207]
    ds_read_b128 v[72:75], v42 offset:1152
    v_mfma_f32_16x16x32_bf16 v[208:211], v[172:175], v[132:135], v[208:211]
    ds_read2_b32 v[104:105], v44 offset0:160 offset1:161
    v_mfma_f32_16x16x32_bf16 v[212:215], v[172:175], v[136:139], v[212:215]
    ds_read2_b32 v[106:107], v44 offset0:162 offset1:163
    v_mfma_f32_16x16x32_bf16 v[216:219], v[172:175], v[140:143], v[216:219]
    ds_read_b128 v[76:79], v42 offset:1664
    buffer_load_dwordx4 a[68:71], v1, s[12:15], s18 offen offset:1024
    s_waitcnt lgkmcnt(15)
    v_mfma_f32_16x16x32_bf16 v[208:211], v[160:163], v[144:147], v[208:211]
    ds_read2_b32 v[108:109], v44 offset0:32 offset1:33
    v_mfma_f32_16x16x32_bf16 v[212:215], v[164:167], v[144:147], v[212:215]
    ds_read2_b32 v[110:111], v44 offset0:34 offset1:35
    v_mfma_f32_16x16x32_bf16 v[216:219], v[168:171], v[144:147], v[216:219]
    ds_read_b128 v[80:83], v42 offset:2176
    v_mfma_f32_16x16x32_bf16 v[220:223], v[172:175], v[144:147], v[220:223]
    ds_read2_b32 v[112:113], v45 offset0:160 offset1:161
    buffer_load_dwordx4 a[72:75], v1, s[12:15], s18 offen offset:2048
    v_mfma_f32_16x16x32_bf16 v[208:211], v[176:179], v[128:131], v[208:211]
    ds_read2_b32 v[114:115], v45 offset0:162 offset1:163
    v_mfma_f32_16x16x32_bf16 v[212:215], v[176:179], v[132:135], v[212:215]
    ds_read_b128 v[84:87], v42 offset:2688
    v_mfma_f32_16x16x32_bf16 v[216:219], v[176:179], v[136:139], v[216:219]
    ds_read2_b32 v[116:117], v45 offset0:32 offset1:33
    v_mfma_f32_16x16x32_bf16 v[220:223], v[176:179], v[140:143], v[220:223]
    ds_read2_b32 v[118:119], v45 offset0:34 offset1:35
    buffer_load_dwordx4 a[76:79], v1, s[12:15], s18 offen offset:3072
    v_mfma_f32_16x16x32_bf16 v[212:215], v[160:163], v[148:151], v[212:215]
    ds_read_b128 v[88:91], v42 offset:3200
    v_mfma_f32_16x16x32_bf16 v[216:219], v[164:167], v[148:151], v[216:219]
    ds_read2_b32 v[120:121], v46 offset0:160 offset1:161
    v_mfma_f32_16x16x32_bf16 v[220:223], v[168:171], v[148:151], v[220:223]
    ds_read2_b32 v[122:123], v46 offset0:162 offset1:163
    v_mfma_f32_16x16x32_bf16 v[212:215], v[180:183], v[128:131], v[212:215]
    ds_read_b128 v[92:95], v42 offset:3712
    s_add_u32 s18, s18, 4096
    buffer_load_dwordx4 a[80:83], v1, s[12:15], s18 offen offset:0
    v_mfma_f32_16x16x32_bf16 v[216:219], v[180:183], v[132:135], v[216:219]
    ds_read2_b32 v[124:125], v46 offset0:32 offset1:33
    v_mfma_f32_16x16x32_bf16 v[220:223], v[180:183], v[136:139], v[220:223]
    ds_read2_b32 v[126:127], v46 offset0:34 offset1:35
    v_mfma_f32_16x16x32_bf16 v[216:219], v[160:163], v[152:155], v[216:219]
    v_mfma_f32_16x16x32_bf16 v[220:223], v[164:167], v[152:155], v[220:223]
    buffer_load_dwordx4 a[84:87], v1, s[12:15], s18 offen offset:1024
    s_waitcnt lgkmcnt(15)
    v_mfma_f32_16x16x32_bf16 v[216:219], v[184:187], v[128:131], v[216:219]
    v_mfma_f32_16x16x32_bf16 v[220:223], v[184:187], v[132:135], v[220:223]
    v_mfma_f32_16x16x32_bf16 v[220:223], v[160:163], v[156:159], v[220:223]
    v_mfma_f32_16x16x32_bf16 v[220:223], v[188:191], v[128:131], v[220:223]
    buffer_load_dwordx4 a[88:91], v1, s[12:15], s18 offen offset:2048
    v_mfma_f32_16x16x32_bf16 v[192:195], v[96:99], v[64:67], v[192:195]
    v_mfma_f32_16x16x32_bf16 v[196:199], v[96:99], v[68:71], v[196:199]
    v_mfma_f32_16x16x32_bf16 v[196:199], v[100:103], v[64:67], v[196:199]
    v_mfma_f32_16x16x32_bf16 v[200:203], v[100:103], v[68:71], v[200:203]
    buffer_load_dwordx4 a[92:95], v1, s[12:15], s18 offen offset:3072
    v_mfma_f32_16x16x32_bf16 v[200:203], v[96:99], v[72:75], v[200:203]
    v_mfma_f32_16x16x32_bf16 v[204:207], v[100:103], v[72:75], v[204:207]
    v_mfma_f32_16x16x32_bf16 v[200:203], v[104:107], v[64:67], v[200:203]
    ds_read_b128 v[128:131], v42 offset:192
    v_mfma_f32_16x16x32_bf16 v[204:207], v[104:107], v[68:71], v[204:207]
    ds_read2_b32 v[160:161], v43 offset0:176 offset1:177
    s_add_u32 s18, s18, 4096
    buffer_load_dwordx4 a[96:99], v1, s[12:15], s18 offen offset:0
    v_mfma_f32_16x16x32_bf16 v[208:211], v[104:107], v[72:75], v[208:211]
    ds_read2_b32 v[162:163], v43 offset0:178 offset1:179
    s_waitcnt lgkmcnt(15)
    v_mfma_f32_16x16x32_bf16 v[204:207], v[96:99], v[76:79], v[204:207]
    ds_read_b128 v[132:135], v42 offset:704
    v_mfma_f32_16x16x32_bf16 v[208:211], v[100:103], v[76:79], v[208:211]
    ds_read2_b32 v[164:165], v43 offset0:48 offset1:49
    v_mfma_f32_16x16x32_bf16 v[212:215], v[104:107], v[76:79], v[212:215]
    ds_read2_b32 v[166:167], v43 offset0:50 offset1:51
    buffer_load_dwordx4 a[100:103], v1, s[12:15], s18 offen offset:1024
    v_mfma_f32_16x16x32_bf16 v[204:207], v[108:111], v[64:67], v[204:207]
    ds_read_b128 v[136:139], v42 offset:1216
    v_mfma_f32_16x16x32_bf16 v[208:211], v[108:111], v[68:71], v[208:211]
    ds_read2_b32 v[168:169], v44 offset0:176 offset1:177
    v_mfma_f32_16x16x32_bf16 v[212:215], v[108:111], v[72:75], v[212:215]
    ds_read2_b32 v[170:171], v44 offset0:178 offset1:179
    v_mfma_f32_16x16x32_bf16 v[216:219], v[108:111], v[76:79], v[216:219]
    ds_read_b128 v[140:143], v42 offset:1728
    buffer_load_dwordx4 a[104:107], v1, s[12:15], s18 offen offset:2048
    s_waitcnt lgkmcnt(15)
    v_mfma_f32_16x16x32_bf16 v[208:211], v[96:99], v[80:83], v[208:211]
    ds_read2_b32 v[172:173], v44 offset0:48 offset1:49
    v_mfma_f32_16x16x32_bf16 v[212:215], v[100:103], v[80:83], v[212:215]
    ds_read2_b32 v[174:175], v44 offset0:50 offset1:51
    v_mfma_f32_16x16x32_bf16 v[216:219], v[104:107], v[80:83], v[216:219]
    ds_read_b128 v[144:147], v42 offset:2240
    v_mfma_f32_16x16x32_bf16 v[220:223], v[108:111], v[80:83], v[220:223]
    ds_read2_b32 v[176:177], v45 offset0:176 offset1:177
    buffer_load_dwordx4 a[108:111], v1, s[12:15], s18 offen offset:3072
    v_mfma_f32_16x16x32_bf16 v[208:211], v[112:115], v[64:67], v[208:211]
    ds_read2_b32 v[178:179], v45 offset0:178 offset1:179
    v_mfma_f32_16x16x32_bf16 v[212:215], v[112:115], v[68:71], v[212:215]
    ds_read_b128 v[148:151], v42 offset:2752
    v_mfma_f32_16x16x32_bf16 v[216:219], v[112:115], v[72:75], v[216:219]
    ds_read2_b32 v[180:181], v45 offset0:48 offset1:49
    v_mfma_f32_16x16x32_bf16 v[220:223], v[112:115], v[76:79], v[220:223]
    ds_read2_b32 v[182:183], v45 offset0:50 offset1:51
    s_add_u32 s18, s18, 4096
    buffer_load_dwordx4 a[112:115], v1, s[12:15], s18 offen offset:0
    v_mfma_f32_16x16x32_bf16 v[212:215], v[96:99], v[84:87], v[212:215]
    ds_read_b128 v[152:155], v42 offset:3264
    v_mfma_f32_16x16x32_bf16 v[216:219], v[100:103], v[84:87], v[216:219]
    ds_read2_b32 v[184:185], v46 offset0:176 offset1:177
    v_mfma_f32_16x16x32_bf16 v[220:223], v[104:107], v[84:87], v[220:223]
    ds_read2_b32 v[186:187], v46 offset0:178 offset1:179
    v_mfma_f32_16x16x32_bf16 v[212:215], v[116:119], v[64:67], v[212:215]
    ds_read_b128 v[156:159], v42 offset:3776
    buffer_load_dwordx4 a[116:119], v1, s[12:15], s18 offen offset:1024
    v_mfma_f32_16x16x32_bf16 v[216:219], v[116:119], v[68:71], v[216:219]
    ds_read2_b32 v[188:189], v46 offset0:48 offset1:49
    v_mfma_f32_16x16x32_bf16 v[220:223], v[116:119], v[72:75], v[220:223]
    ds_read2_b32 v[190:191], v46 offset0:50 offset1:51
    v_mfma_f32_16x16x32_bf16 v[216:219], v[96:99], v[88:91], v[216:219]
    s_lshl_b32 s49, s6, 12
    v_add_u32 v38, s49, v1
    s_xor_b32 s49, s49, 4096
    v_add_u32 v37, s49, v1
    v_lshlrev_b32 v39, 5, v40
    v_mfma_f32_16x16x32_bf16 v[220:223], v[100:103], v[88:91], v[220:223]
    buffer_load_dwordx4 a[120:123], v1, s[12:15], s18 offen offset:2048
    v_lshl_add_u32 v39, v41, 3, v39
    s_lshl_b32 s50, s48, 11
    v_add_u32 v39, s50, v39
    s_mul_i32 s51, s38, 4576
    s_add_u32 s51, s51, 128736
    s_waitcnt lgkmcnt(15)
    v_mfma_f32_16x16x32_bf16 v[216:219], v[120:123], v[64:67], v[216:219]
    v_add_u32 v30, s51, v39
    s_lshl_b32 s51, s38, 12
    s_add_u32 s52, s51, 137408
    v_add_u32 v31, s52, v39
    s_lshl_b32 s52, s2, 1
    v_mfma_f32_16x16x32_bf16 v[220:223], v[120:123], v[68:71], v[220:223]
    s_add_u32 s52, s52, s38
    s_mul_i32 s52, s52, 4224
    s_add_u32 s52, s52, s50
    s_add_u32 s52, s52, 7340032
    v_lshlrev_b32 v32, 5, v40
    v_mfma_f32_16x16x32_bf16 v[220:223], v[96:99], v[92:95], v[220:223]
    v_and_b32 v33, 1, v41
    v_lshl_add_u32 v32, v33, 9, v32
    v_lshrrev_b32 v33, 1, v41
    v_lshl_add_u32 v32, v33, 4, v32
    v_add_u32 v32, s52, v32
    v_mfma_f32_16x16x32_bf16 v[220:223], v[124:127], v[64:67], v[220:223]
    buffer_load_dwordx4 a[124:127], v1, s[12:15], s18 offen offset:3072
    v_mfma_f32_16x16x32_bf16 v[192:195], v[160:163], v[128:131], v[192:195]
    ds_read_b64 v[48:49], v30 offset:0
    v_mfma_f32_16x16x32_bf16 v[196:199], v[160:163], v[132:135], v[196:199]
    ds_read_b64 v[56:57], v31 offset:0
    v_mfma_f32_16x16x32_bf16 v[196:199], v[164:167], v[128:131], v[196:199]
    ds_read_b64 v[50:51], v30 offset:512
    v_mfma_f32_16x16x32_bf16 v[200:203], v[164:167], v[132:135], v[200:203]
    s_add_u32 s18, s18, 4096
    buffer_load_dwordx4 a[128:131], v1, s[12:15], s18 offen offset:0
    ds_read_b64 v[58:59], v31 offset:512
    v_mfma_f32_16x16x32_bf16 v[200:203], v[160:163], v[136:139], v[200:203]
    ds_read_b64 v[52:53], v30 offset:1024
    v_mfma_f32_16x16x32_bf16 v[204:207], v[164:167], v[136:139], v[204:207]
    ds_read_b64 v[60:61], v31 offset:1024
    v_mfma_f32_16x16x32_bf16 v[200:203], v[168:171], v[128:131], v[200:203]
    ds_read_b64 v[54:55], v30 offset:1536
    v_mfma_f32_16x16x32_bf16 v[204:207], v[168:171], v[132:135], v[204:207]
    buffer_load_dwordx4 a[132:135], v1, s[12:15], s18 offen offset:1024
    ds_read_b64 v[62:63], v31 offset:1536
    v_mfma_f32_16x16x32_bf16 v[208:211], v[168:171], v[136:139], v[208:211]
    s_waitcnt lgkmcnt(15)
    v_mfma_f32_16x16x32_bf16 v[204:207], v[160:163], v[140:143], v[204:207]
    v_mfma_f32_16x16x32_bf16 v[208:211], v[164:167], v[140:143], v[208:211]
    v_mfma_f32_16x16x32_bf16 v[212:215], v[168:171], v[140:143], v[212:215]
    buffer_load_dwordx4 a[136:139], v1, s[12:15], s18 offen offset:2048
    v_mfma_f32_16x16x32_bf16 v[204:207], v[172:175], v[128:131], v[204:207]
    v_mfma_f32_16x16x32_bf16 v[208:211], v[172:175], v[132:135], v[208:211]
    v_mfma_f32_16x16x32_bf16 v[212:215], v[172:175], v[136:139], v[212:215]
    s_waitcnt lgkmcnt(0)
    v_lshlrev_b32 v64, 16, v48
    v_and_b32 v65, 0xffff0000, v48
    v_mfma_f32_16x16x32_bf16 v[216:219], v[172:175], v[140:143], v[216:219]
    buffer_load_dwordx4 a[140:143], v1, s[12:15], s18 offen offset:3072
    v_lshlrev_b32 v80, 16, v56
    v_and_b32 v81, 0xffff0000, v56
    v_mfma_f32_16x16x32_bf16 v[208:211], v[160:163], v[144:147], v[208:211]
    v_lshlrev_b32 v66, 16, v49
    v_and_b32 v67, 0xffff0000, v49
    v_mfma_f32_16x16x32_bf16 v[212:215], v[164:167], v[144:147], v[212:215]
    v_lshlrev_b32 v82, 16, v57
    v_and_b32 v83, 0xffff0000, v57
    v_mfma_f32_16x16x32_bf16 v[216:219], v[168:171], v[144:147], v[216:219]
    v_lshlrev_b32 v68, 16, v50
    v_and_b32 v69, 0xffff0000, v50
    v_mfma_f32_16x16x32_bf16 v[220:223], v[172:175], v[144:147], v[220:223]
    s_add_u32 s18, s18, 4096
    buffer_load_dwordx4 a[144:147], v1, s[12:15], s18 offen offset:0
    v_lshlrev_b32 v84, 16, v58
    v_and_b32 v85, 0xffff0000, v58
    v_mfma_f32_16x16x32_bf16 v[208:211], v[176:179], v[128:131], v[208:211]
    v_lshlrev_b32 v70, 16, v51
    v_and_b32 v71, 0xffff0000, v51
    v_mfma_f32_16x16x32_bf16 v[212:215], v[176:179], v[132:135], v[212:215]
    v_lshlrev_b32 v86, 16, v59
    v_and_b32 v87, 0xffff0000, v59
    v_mfma_f32_16x16x32_bf16 v[216:219], v[176:179], v[136:139], v[216:219]
    v_lshlrev_b32 v72, 16, v52
    v_and_b32 v73, 0xffff0000, v52
    v_mfma_f32_16x16x32_bf16 v[220:223], v[176:179], v[140:143], v[220:223]
    v_lshlrev_b32 v88, 16, v60
    v_and_b32 v89, 0xffff0000, v60
    v_mfma_f32_16x16x32_bf16 v[212:215], v[160:163], v[148:151], v[212:215]
    v_lshlrev_b32 v74, 16, v53
    v_and_b32 v75, 0xffff0000, v53
    v_mfma_f32_16x16x32_bf16 v[216:219], v[164:167], v[148:151], v[216:219]
    v_lshlrev_b32 v90, 16, v61
    v_and_b32 v91, 0xffff0000, v61
    v_mfma_f32_16x16x32_bf16 v[220:223], v[168:171], v[148:151], v[220:223]
    v_lshlrev_b32 v76, 16, v54
    v_and_b32 v77, 0xffff0000, v54
    v_mfma_f32_16x16x32_bf16 v[212:215], v[180:183], v[128:131], v[212:215]
    v_lshlrev_b32 v92, 16, v62
    v_and_b32 v93, 0xffff0000, v62
    v_mfma_f32_16x16x32_bf16 v[216:219], v[180:183], v[132:135], v[216:219]
    v_lshlrev_b32 v78, 16, v55
    v_and_b32 v79, 0xffff0000, v55
    v_mfma_f32_16x16x32_bf16 v[220:223], v[180:183], v[136:139], v[220:223]
    v_lshlrev_b32 v94, 16, v63
    v_and_b32 v95, 0xffff0000, v63
    v_mfma_f32_16x16x32_bf16 v[216:219], v[160:163], v[152:155], v[216:219]
    v_mfma_f32_16x16x32_bf16 v[220:223], v[164:167], v[152:155], v[220:223]
    v_mfma_f32_16x16x32_bf16 v[216:219], v[184:187], v[128:131], v[216:219]
    v_mfma_f32_16x16x32_bf16 v[220:223], v[184:187], v[132:135], v[220:223]
    v_mfma_f32_16x16x32_bf16 v[220:223], v[160:163], v[156:159], v[220:223]
    v_mfma_f32_16x16x32_bf16 v[220:223], v[188:191], v[128:131], v[220:223]
    s_cmp_eq_u32 s48, 0
    s_cbranch_scc1 F_h0
    s_nop 4
    ds_write_b128 v38, v[192:195] offset:0
    ds_write_b128 v38, v[196:199] offset:1024
    ds_write_b128 v38, v[200:203] offset:2048
    ds_write_b128 v38, v[204:207] offset:3072
    v_fma_f32 v64, s29, v64, v208
    v_fma_f32 v65, s29, v65, v209
    v_fma_f32 v66, s29, v66, v210
    v_fma_f32 v67, s29, v67, v211
    v_fma_f32 v68, s29, v68, v212
    v_fma_f32 v69, s29, v69, v213
    v_fma_f32 v70, s29, v70, v214
    v_fma_f32 v71, s29, v71, v215
    v_fma_f32 v72, s29, v72, v216
    v_fma_f32 v73, s29, v73, v217
    v_fma_f32 v74, s29, v74, v218
    v_fma_f32 v75, s29, v75, v219
    v_fma_f32 v76, s29, v76, v220
    v_fma_f32 v77, s29, v77, v221
    v_fma_f32 v78, s29, v78, v222
    v_fma_f32 v79, s29, v79, v223
    s_branch F_h1
F_h0:
    s_nop 4
    ds_write_b128 v38, v[208:211] offset:0
    ds_write_b128 v38, v[212:215] offset:1024
    ds_write_b128 v38, v[216:219] offset:2048
    ds_write_b128 v38, v[220:223] offset:3072
    v_fma_f32 v64, s29, v64, v192
    v_fma_f32 v65, s29, v65, v193
    v_fma_f32 v66, s29, v66, v194
    v_fma_f32 v67, s29, v67, v195
    v_fma_f32 v68, s29, v68, v196
    v_fma_f32 v69, s29, v69, v197
    v_fma_f32 v70, s29, v70, v198
    v_fma_f32 v71, s29, v71, v199
    v_fma_f32 v72, s29, v72, v200
    v_fma_f32 v73, s29, v73, v201
    v_fma_f32 v74, s29, v74, v202
    v_fma_f32 v75, s29, v75, v203
    v_fma_f32 v76, s29, v76, v204
    v_fma_f32 v77, s29, v77, v205
    v_fma_f32 v78, s29, v78, v206
    v_fma_f32 v79, s29, v79, v207
F_h1:
    s_waitcnt lgkmcnt(0)
    s_barrier
    ds_read_b128 v[96:99], v37 offset:0
    ds_read_b128 v[100:103], v37 offset:1024
    ds_read_b128 v[104:107], v37 offset:2048
    ds_read_b128 v[108:111], v37 offset:3072
    s_waitcnt lgkmcnt(3)
    v_add_f32 v64, v64, v96
    v_add_f32 v65, v65, v97
    v_add_f32 v66, v66, v98
    v_add_f32 v67, v67, v99
    v_fmac_f32 v80, s36, v64
    v_fmac_f32 v81, s36, v65
    v_fmac_f32 v82, s36, v66
    v_fmac_f32 v83, s36, v67
    v_cvt_pk_bf16_f32 v112, v80, v81
    v_cvt_pk_bf16_f32 v113, v82, v83
    s_waitcnt lgkmcnt(2)
    v_add_f32 v68, v68, v100
    v_add_f32 v69, v69, v101
    v_add_f32 v70, v70, v102
    v_add_f32 v71, v71, v103
    v_fmac_f32 v84, s36, v68
    v_fmac_f32 v85, s36, v69
    v_fmac_f32 v86, s36, v70
    v_fmac_f32 v87, s36, v71
    v_cvt_pk_bf16_f32 v114, v84, v85
    v_cvt_pk_bf16_f32 v115, v86, v87
    s_nop 0
    v_permlane16_swap_b32 v112, v114
    v_permlane16_swap_b32 v113, v115
    global_store_dwordx4 v32, v[112:115], s[8:9] offset:0 sc1
    s_waitcnt lgkmcnt(1)
    v_add_f32 v72, v72, v104
    v_add_f32 v73, v73, v105
    v_add_f32 v74, v74, v106
    v_add_f32 v75, v75, v107
    v_fmac_f32 v88, s36, v72
    v_fmac_f32 v89, s36, v73
    v_fmac_f32 v90, s36, v74
    v_fmac_f32 v91, s36, v75
    v_cvt_pk_bf16_f32 v116, v88, v89
    v_cvt_pk_bf16_f32 v117, v90, v91
    s_waitcnt lgkmcnt(0)
    v_add_f32 v76, v76, v108
    v_add_f32 v77, v77, v109
    v_add_f32 v78, v78, v110
    v_add_f32 v79, v79, v111
    v_fmac_f32 v92, s36, v76
    v_fmac_f32 v93, s36, v77
    v_fmac_f32 v94, s36, v78
    v_fmac_f32 v95, s36, v79
    v_cvt_pk_bf16_f32 v118, v92, v93
    v_cvt_pk_bf16_f32 v119, v94, v95
    s_nop 0
    v_permlane16_swap_b32 v116, v118
    v_permlane16_swap_b32 v117, v119
    global_store_dwordx4 v32, v[116:119], s[8:9] offset:1024 sc1
    v_lshrrev_b32 v5, 3, v0
    v_and_b32 v6, 7, v0
    v_mul_u32_u24 v7, 4224, v5
    v_lshl_add_u32 v7, v6, 4, v7
    v_mul_u32_u24 v8, 112, v5
    v_add_u32 v8, 2195456, v8
    s_lshl_b32 s7, s4, 7
    s_add_u32 s7, s7, 7340032
    s_mul_i32 s16, s5, 270336
    s_add_u32 s16, s16, s7
    s_lshr_b32 s20, s6, 1
    s_lshl_b32 s20, s20, 10
    v_add_u32 v12, s20, v1
    v_xor_b32 v13, 1024, v12
    s_and_b32 s21, s6, 1
    s_lshl_b32 s21, s21, 10
    v_add_u32 v14, s21, v1
    v_xor_b32 v15, 1024, v14
    s_mul_i32 s17, s4, 28
    s_add_u32 s17, s17, s6
    s_lshl_b32 s17, s17, 13
    s_add_u32 s17, s17, 9437184
    s_add_u32 s23, s5, 0
    s_sub_u32 s24, s23, 7
    s_cmp_ge_u32 s23, 7
    s_cselect_b32 s23, s24, s23
    s_lshl_b32 s24, s23, 13
    s_add_u32 s40, s19, s24
    s_lshl_b32 s24, s23, 15
    s_add_u32 s50, s17, s24
    s_add_u32 s23, s5, 1
    s_sub_u32 s24, s23, 7
    s_cmp_ge_u32 s23, 7
    s_cselect_b32 s23, s24, s23
    s_lshl_b32 s24, s23, 13
    s_add_u32 s41, s19, s24
    s_lshl_b32 s24, s23, 15
    s_add_u32 s51, s17, s24
    s_add_u32 s23, s5, 2
    s_sub_u32 s24, s23, 7
    s_cmp_ge_u32 s23, 7
    s_cselect_b32 s23, s24, s23
    s_lshl_b32 s24, s23, 13
    s_add_u32 s42, s19, s24
    s_lshl_b32 s24, s23, 15
    s_add_u32 s52, s17, s24
    s_add_u32 s23, s5, 3
    s_sub_u32 s24, s23, 7
    s_cmp_ge_u32 s23, 7
    s_cselect_b32 s23, s24, s23
    s_lshl_b32 s24, s23, 13
    s_add_u32 s43, s19, s24
    s_lshl_b32 s24, s23, 15
    s_add_u32 s53, s17, s24
    s_add_u32 s23, s5, 4
    s_sub_u32 s24, s23, 7
    s_cmp_ge_u32 s23, 7
    s_cselect_b32 s23, s24, s23
    s_lshl_b32 s24, s23, 13
    s_add_u32 s44, s19, s24
    s_lshl_b32 s24, s23, 15
    s_add_u32 s54, s17, s24
    s_add_u32 s23, s5, 5
    s_sub_u32 s24, s23, 7
    s_cmp_ge_u32 s23, 7
    s_cselect_b32 s23, s24, s23
    s_lshl_b32 s24, s23, 13
    s_add_u32 s45, s19, s24
    s_lshl_b32 s24, s23, 15
    s_add_u32 s55, s17, s24
    s_add_u32 s23, s5, 6
    s_sub_u32 s24, s23, 7
    s_cmp_ge_u32 s23, 7
    s_cselect_b32 s23, s24, s23
    s_lshl_b32 s24, s23, 13
    s_add_u32 s46, s19, s24
    s_lshl_b32 s24, s23, 15
    s_add_u32 s56, s17, s24
    v_lshlrev_b32 v9, 4, v0
    v_bfe_u32 v10, v0, 4, 1
    v_lshlrev_b32 v10, 6, v10
    v_xor_b32 v9, v9, v10
    v_bfe_u32 v10, v0, 5, 1
    v_bfe_u32 v11, v0, 2, 2
    v_lshl_add_u32 v2, v10, 3, v11
    v_lshlrev_b32 v2, 7, v2
    v_bfe_u32 v60, v0, 4, 1
    v_lshl_add_u32 v2, v60, 5, v2
    v_and_b32 v60, 3, v0
    v_lshl_add_u32 v2, v60, 3, v2
    v_bfe_u32 v60, v0, 3, 1
    v_lshlrev_b32 v60, 6, v60
    v_xor_b32 v2, v2, v60
    s_lshr_b32 s21, s21, 4
    v_xor_b32 v2, s21, v2
    v_xor_b32 v3, 64, v2
    s_lshl_b32 s3, s2, 6
    s_add_u32 s3, s3, 2326528
    v_mov_b32 v16, s3
    v_mov_b32 v17, s33
    v_lshrrev_b32 v11, 4, v1
    v_min_u32 v60, 27, v11
    v_lshlrev_b32 v60, 6, v60
    v_add_u32 v28, 2394112, v60
    v_add_u32 v60, 2340864, v60
    s_lshr_b32 s22, s2, 3
    s_mul_i32 s22, s22, 57344
    s_mul_i32 s23, s6, 14336
    s_add_u32 s22, s22, s23
    s_add_u32 s22, s22, 5242880
    v_lshlrev_b32 v61, 7, v11
    v_add_u32 v61, s22, v61
    global_load_dword v29, v28, s[8:9] sc1
    s_waitcnt vmcnt(0)
    s_barrier
    s_cmp_lg_u32 s6, 3
    s_cbranch_scc1 M_noflag
    s_mov_b64 exec, 1
    global_store_dword v16, v17, s[8:9] sc1
    s_mov_b64 exec, -1
M_noflag:
    s_mov_b32 s35, 0
M_pollD:
    v_cmp_ne_u32 vcc, s33, v29
    s_add_u32 s35, s35, 1
    s_nop 3
    s_cbranch_vccz M_pollD_done
    s_sleep 2
    global_load_dword v29, v28, s[8:9] sc1
    s_cmp_lt_u32 s35, 0x100000
    s_waitcnt vmcnt(0)
    s_cbranch_scc1 M_pollD
M_pollD_done:
    buffer_load_dwordx4 a[148:151], v1, s[12:15], s18 offen offset:1024
    buffer_load_dwordx4 a[152:155], v1, s[12:15], s18 offen offset:2048
    buffer_load_dwordx4 a[156:159], v1, s[12:15], s18 offen offset:3072
    s_add_u32 s18, s18, 4096
    buffer_load_dwordx4 a[160:163], v1, s[12:15], s18 offen offset:0
    buffer_load_dwordx4 a[164:167], v1, s[12:15], s18 offen offset:1024
    buffer_load_dwordx4 a[168:171], v1, s[12:15], s18 offen offset:2048
    buffer_load_dwordx4 a[172:175], v1, s[12:15], s18 offen offset:3072
    s_add_u32 s18, s18, 4096
    buffer_load_dwordx4 a[176:179], v1, s[12:15], s18 offen offset:0
    buffer_load_dwordx4 a[180:183], v1, s[12:15], s18 offen offset:1024
    buffer_load_dwordx4 a[184:187], v1, s[12:15], s18 offen offset:2048
    buffer_load_dwordx4 a[188:191], v1, s[12:15], s18 offen offset:3072
    s_add_u32 s18, s18, 4096
    buffer_load_dwordx4 a[192:195], v1, s[12:15], s18 offen offset:0
    buffer_load_dwordx4 a[196:199], v1, s[12:15], s18 offen offset:1024
    buffer_load_dwordx4 a[200:203], v1, s[12:15], s18 offen offset:2048
    buffer_load_dwordx4 a[204:207], v1, s[12:15], s18 offen offset:3072
    s_add_u32 s18, s18, 4096
    buffer_load_dwordx4 a[208:211], v1, s[12:15], s18 offen offset:0
    v_min_u32 v20, 223, v0
    v_lshlrev_b32 v20, 6, v20
    v_add_u32 v20, 2326528, v20
    global_load_dword v24, v20, s[8:9] sc1
    s_waitcnt vmcnt(0)
    s_mov_b32 s35, 0
M_pollB:
    v_cmp_ne_u32 vcc, s33, v24
    s_add_u32 s35, s35, 1
    s_nop 3
    s_cbranch_vccz M_pollB_done
    s_sleep 2
    global_load_dword v24, v20, s[8:9] sc1
    s_cmp_lt_u32 s35, 0x100000
    s_waitcnt vmcnt(0)
    s_cbranch_scc1 M_pollB
M_pollB_done:
    s_barrier
    buffer_load_dwordx4 v[64:67], v7, s[12:15], s7 offen
    s_add_u32 s7, s7, 135168
    buffer_load_dwordx4 v[68:71], v7, s[12:15], s7 offen
    s_add_u32 s7, s7, 135168
    buffer_load_dwordx4 v[72:75], v7, s[12:15], s7 offen
    s_add_u32 s7, s7, 135168
    buffer_load_dwordx4 v[76:79], v7, s[12:15], s7 offen
    s_add_u32 s7, s7, 135168
    buffer_load_dwordx4 v[80:83], v7, s[12:15], s7 offen
    s_add_u32 s7, s7, 135168
    buffer_load_dwordx4 v[84:87], v7, s[12:15], s7 offen
    s_add_u32 s7, s7, 135168
    buffer_load_dwordx4 v[88:91], v7, s[12:15], s7 offen
    s_add_u32 s7, s7, 135168
    buffer_load_dwordx4 v[92:95], v7, s[12:15], s7 offen
    s_add_u32 s7, s7, 135168
    global_load_dword v63, v60, s[8:9] sc1
    v_mov_b32 v16, 0
    v_mov_b32 v17, 0
    v_mov_b32 v18, 0
    v_mov_b32 v19, 0
    v_mov_b32 v20, 0
    v_mov_b32 v21, 0
    v_mov_b32 v22, 0
    v_mov_b32 v23, 0
    v_mov_b32 v24, 0
    v_mov_b32 v25, 0
    v_mov_b32 v26, 0
    v_mov_b32 v27, 0
    v_mov_b32 v28, 0
    v_mov_b32 v29, 0
    v_mov_b32 v30, 0
    v_mov_b32 v31, 0
    s_waitcnt vmcnt(8)
    buffer_load_dwordx4 v[96:99], v7, s[12:15], s7 offen
    s_add_u32 s7, s7, 135168
    v_lshlrev_b32 v128, 16, v64
    v_and_b32 v129, 0xffff0000, v64
    v_lshlrev_b32 v130, 16, v65
    v_and_b32 v131, 0xffff0000, v65
    v_lshlrev_b32 v132, 16, v66
    v_and_b32 v133, 0xffff0000, v66
    v_lshlrev_b32 v134, 16, v67
    v_and_b32 v135, 0xffff0000, v67
    v_pk_add_f32 v[16:17], v[16:17], v[128:129]
    v_pk_fma_f32 v[24:25], v[128:129], v[128:129], v[24:25]
    v_pk_add_f32 v[18:19], v[18:19], v[130:131]
    v_pk_fma_f32 v[26:27], v[130:131], v[130:131], v[26:27]
    v_pk_add_f32 v[20:21], v[20:21], v[132:133]
    v_pk_fma_f32 v[28:29], v[132:133], v[132:133], v[28:29]
    v_pk_add_f32 v[22:23], v[22:23], v[134:135]
    v_pk_fma_f32 v[30:31], v[134:135], v[134:135], v[30:31]
    s_waitcnt vmcnt(8)
    buffer_load_dwordx4 v[100:103], v7, s[12:15], s7 offen
    s_add_u32 s7, s7, 135168
    v_lshlrev_b32 v136, 16, v68
    v_and_b32 v137, 0xffff0000, v68
    v_lshlrev_b32 v138, 16, v69
    v_and_b32 v139, 0xffff0000, v69
    v_lshlrev_b32 v140, 16, v70
    v_and_b32 v141, 0xffff0000, v70
    v_lshlrev_b32 v142, 16, v71
    v_and_b32 v143, 0xffff0000, v71
    v_pk_add_f32 v[16:17], v[16:17], v[136:137]
    v_pk_fma_f32 v[24:25], v[136:137], v[136:137], v[24:25]
    v_pk_add_f32 v[18:19], v[18:19], v[138:139]
    v_pk_fma_f32 v[26:27], v[138:139], v[138:139], v[26:27]
    v_pk_add_f32 v[20:21], v[20:21], v[140:141]
    v_pk_fma_f32 v[28:29], v[140:141], v[140:141], v[28:29]
    v_pk_add_f32 v[22:23], v[22:23], v[142:143]
    v_pk_fma_f32 v[30:31], v[142:143], v[142:143], v[30:31]
    s_waitcnt vmcnt(8)
    buffer_load_dwordx4 v[104:107], v7, s[12:15], s7 offen
    s_add_u32 s7, s7, 135168
    v_lshlrev_b32 v144, 16, v72
    v_and_b32 v145, 0xffff0000, v72
    v_lshlrev_b32 v146, 16, v73
    v_and_b32 v147, 0xffff0000, v73
    v_lshlrev_b32 v148, 16, v74
    v_and_b32 v149, 0xffff0000, v74
    v_lshlrev_b32 v150, 16, v75
    v_and_b32 v151, 0xffff0000, v75
    v_pk_add_f32 v[16:17], v[16:17], v[144:145]
    v_pk_fma_f32 v[24:25], v[144:145], v[144:145], v[24:25]
    v_pk_add_f32 v[18:19], v[18:19], v[146:147]
    v_pk_fma_f32 v[26:27], v[146:147], v[146:147], v[26:27]
    v_pk_add_f32 v[20:21], v[20:21], v[148:149]
    v_pk_fma_f32 v[28:29], v[148:149], v[148:149], v[28:29]
    v_pk_add_f32 v[22:23], v[22:23], v[150:151]
    v_pk_fma_f32 v[30:31], v[150:151], v[150:151], v[30:31]
    s_waitcnt vmcnt(8)
    buffer_load_dwordx4 v[108:111], v7, s[12:15], s7 offen
    s_add_u32 s7, s7, 135168
    v_lshlrev_b32 v152, 16, v76
    v_and_b32 v153, 0xffff0000, v76
    v_lshlrev_b32 v154, 16, v77
    v_and_b32 v155, 0xffff0000, v77
    v_lshlrev_b32 v156, 16, v78
    v_and_b32 v157, 0xffff0000, v78
    v_lshlrev_b32 v158, 16, v79
    v_and_b32 v159, 0xffff0000, v79
    v_pk_add_f32 v[16:17], v[16:17], v[152:153]
    v_pk_fma_f32 v[24:25], v[152:153], v[152:153], v[24:25]
    v_pk_add_f32 v[18:19], v[18:19], v[154:155]
    v_pk_fma_f32 v[26:27], v[154:155], v[154:155], v[26:27]
    v_pk_add_f32 v[20:21], v[20:21], v[156:157]
    v_pk_fma_f32 v[28:29], v[156:157], v[156:157], v[28:29]
    v_pk_add_f32 v[22:23], v[22:23], v[158:159]
    v_pk_fma_f32 v[30:31], v[158:159], v[158:159], v[30:31]
    s_waitcnt vmcnt(8)
    buffer_load_dwordx4 v[112:115], v7, s[12:15], s7 offen
    s_add_u32 s7, s7, 135168
    v_lshlrev_b32 v160, 16, v80
    v_and_b32 v161, 0xffff0000, v80
    v_lshlrev_b32 v162, 16, v81
    v_and_b32 v163, 0xffff0000, v81
    v_lshlrev_b32 v164, 16, v82
    v_and_b32 v165, 0xffff0000, v82
    v_lshlrev_b32 v166, 16, v83
    v_and_b32 v167, 0xffff0000, v83
    v_pk_add_f32 v[16:17], v[16:17], v[160:161]
    v_pk_fma_f32 v[24:25], v[160:161], v[160:161], v[24:25]
    v_pk_add_f32 v[18:19], v[18:19], v[162:163]
    v_pk_fma_f32 v[26:27], v[162:163], v[162:163], v[26:27]
    v_pk_add_f32 v[20:21], v[20:21], v[164:165]
    v_pk_fma_f32 v[28:29], v[164:165], v[164:165], v[28:29]
    v_pk_add_f32 v[22:23], v[22:23], v[166:167]
    v_pk_fma_f32 v[30:31], v[166:167], v[166:167], v[30:31]
    s_waitcnt vmcnt(8)
    buffer_load_dwordx4 v[116:119], v7, s[12:15], s7 offen
    s_add_u32 s7, s7, 135168
    v_lshlrev_b32 v168, 16, v84
    v_and_b32 v169, 0xffff0000, v84
    v_lshlrev_b32 v170, 16, v85
    v_and_b32 v171, 0xffff0000, v85
    v_lshlrev_b32 v172, 16, v86
    v_and_b32 v173, 0xffff0000, v86
    v_lshlrev_b32 v174, 16, v87
    v_and_b32 v175, 0xffff0000, v87
    v_pk_add_f32 v[16:17], v[16:17], v[168:169]
    v_pk_fma_f32 v[24:25], v[168:169], v[168:169], v[24:25]
    v_pk_add_f32 v[18:19], v[18:19], v[170:171]
    v_pk_fma_f32 v[26:27], v[170:171], v[170:171], v[26:27]
    v_pk_add_f32 v[20:21], v[20:21], v[172:173]
    v_pk_fma_f32 v[28:29], v[172:173], v[172:173], v[28:29]
    v_pk_add_f32 v[22:23], v[22:23], v[174:175]
    v_pk_fma_f32 v[30:31], v[174:175], v[174:175], v[30:31]
    s_waitcnt vmcnt(8)
    buffer_load_dwordx4 v[120:123], v7, s[12:15], s16 offen
    s_add_u32 s16, s16, 135168
    v_lshlrev_b32 v176, 16, v88
    v_and_b32 v177, 0xffff0000, v88
    v_lshlrev_b32 v178, 16, v89
    v_and_b32 v179, 0xffff0000, v89
    v_lshlrev_b32 v180, 16, v90
    v_and_b32 v181, 0xffff0000, v90
    v_lshlrev_b32 v182, 16, v91
    v_and_b32 v183, 0xffff0000, v91
    buffer_load_dwordx4 v[124:127], v7, s[12:15], s16 offen
    v_pk_add_f32 v[16:17], v[16:17], v[176:177]
    v_pk_fma_f32 v[24:25], v[176:177], v[176:177], v[24:25]
    v_pk_add_f32 v[18:19], v[18:19], v[178:179]
    v_pk_fma_f32 v[26:27], v[178:179], v[178:179], v[26:27]
    v_pk_add_f32 v[20:21], v[20:21], v[180:181]
    v_pk_fma_f32 v[28:29], v[180:181], v[180:181], v[28:29]
    v_pk_add_f32 v[22:23], v[22:23], v[182:183]
    v_pk_fma_f32 v[30:31], v[182:183], v[182:183], v[30:31]
    s_waitcnt vmcnt(9)
    s_waitcnt vmcnt(8)
    s_mov_b32 s35, 0
M_pollF:
    v_cmp_ne_u32 vcc, s33, v63
    s_add_u32 s35, s35, 1
    s_nop 3
    s_cbranch_vccz M_pollF_done
    s_sleep 2
    global_load_dword v63, v60, s[8:9] sc1
    s_cmp_lt_u32 s35, 0x100000
    s_waitcnt vmcnt(0)
    s_cbranch_scc1 M_pollF
M_pollF_done:
    global_load_dwordx4 v[32:35], v8, s[8:9] offset:0
    v_lshlrev_b32 v184, 16, v92
    v_and_b32 v185, 0xffff0000, v92
    v_lshlrev_b32 v186, 16, v93
    v_and_b32 v187, 0xffff0000, v93
    v_lshlrev_b32 v188, 16, v94
    v_and_b32 v189, 0xffff0000, v94
    v_lshlrev_b32 v190, 16, v95
    v_and_b32 v191, 0xffff0000, v95
    global_load_dwordx4 v[36:39], v8, s[8:9] offset:16
    v_pk_add_f32 v[16:17], v[16:17], v[184:185]
    v_pk_fma_f32 v[24:25], v[184:185], v[184:185], v[24:25]
    v_pk_add_f32 v[18:19], v[18:19], v[186:187]
    v_pk_fma_f32 v[26:27], v[186:187], v[186:187], v[26:27]
    v_pk_add_f32 v[20:21], v[20:21], v[188:189]
    v_pk_fma_f32 v[28:29], v[188:189], v[188:189], v[28:29]
    v_pk_add_f32 v[22:23], v[22:23], v[190:191]
    v_pk_fma_f32 v[30:31], v[190:191], v[190:191], v[30:31]
    s_waitcnt vmcnt(9)
    global_load_dwordx4 v[40:43], v8, s[8:9] offset:32
    v_lshlrev_b32 v192, 16, v96
    v_and_b32 v193, 0xffff0000, v96
    v_lshlrev_b32 v194, 16, v97
    v_and_b32 v195, 0xffff0000, v97
    v_lshlrev_b32 v196, 16, v98
    v_and_b32 v197, 0xffff0000, v98
    v_lshlrev_b32 v198, 16, v99
    v_and_b32 v199, 0xffff0000, v99
    global_load_dwordx4 v[44:47], v8, s[8:9] offset:48
    v_pk_add_f32 v[16:17], v[16:17], v[192:193]
    v_pk_fma_f32 v[24:25], v[192:193], v[192:193], v[24:25]
    v_pk_add_f32 v[18:19], v[18:19], v[194:195]
    v_pk_fma_f32 v[26:27], v[194:195], v[194:195], v[26:27]
    v_pk_add_f32 v[20:21], v[20:21], v[196:197]
    v_pk_fma_f32 v[28:29], v[196:197], v[196:197], v[28:29]
    v_pk_add_f32 v[22:23], v[22:23], v[198:199]
    v_pk_fma_f32 v[30:31], v[198:199], v[198:199], v[30:31]
    s_waitcnt vmcnt(10)
    global_load_dwordx4 v[48:51], v8, s[8:9] offset:64
    v_lshlrev_b32 v200, 16, v100
    v_and_b32 v201, 0xffff0000, v100
    v_lshlrev_b32 v202, 16, v101
    v_and_b32 v203, 0xffff0000, v101
    v_lshlrev_b32 v204, 16, v102
    v_and_b32 v205, 0xffff0000, v102
    v_lshlrev_b32 v206, 16, v103
    v_and_b32 v207, 0xffff0000, v103
    global_load_dwordx4 v[52:55], v8, s[8:9] offset:80
    v_pk_add_f32 v[16:17], v[16:17], v[200:201]
    v_pk_fma_f32 v[24:25], v[200:201], v[200:201], v[24:25]
    v_pk_add_f32 v[18:19], v[18:19], v[202:203]
    v_pk_fma_f32 v[26:27], v[202:203], v[202:203], v[26:27]
    v_pk_add_f32 v[20:21], v[20:21], v[204:205]
    v_pk_fma_f32 v[28:29], v[204:205], v[204:205], v[28:29]
    v_pk_add_f32 v[22:23], v[22:23], v[206:207]
    v_pk_fma_f32 v[30:31], v[206:207], v[206:207], v[30:31]
    s_waitcnt vmcnt(11)
    global_load_dwordx4 v[56:59], v8, s[8:9] offset:96
    v_lshlrev_b32 v208, 16, v104
    v_and_b32 v209, 0xffff0000, v104
    v_lshlrev_b32 v210, 16, v105
    v_and_b32 v211, 0xffff0000, v105
    v_lshlrev_b32 v212, 16, v106
    v_and_b32 v213, 0xffff0000, v106
    v_lshlrev_b32 v214, 16, v107
    v_and_b32 v215, 0xffff0000, v107
    buffer_load_dwordx4 a[212:215], v1, s[12:15], s18 offen offset:1024
    v_pk_add_f32 v[16:17], v[16:17], v[208:209]
    v_pk_fma_f32 v[24:25], v[208:209], v[208:209], v[24:25]
    v_pk_add_f32 v[18:19], v[18:19], v[210:211]
    v_pk_fma_f32 v[26:27], v[210:211], v[210:211], v[26:27]
    v_pk_add_f32 v[20:21], v[20:21], v[212:213]
    v_pk_fma_f32 v[28:29], v[212:213], v[212:213], v[28:29]
    v_pk_add_f32 v[22:23], v[22:23], v[214:215]
    v_pk_fma_f32 v[30:31], v[214:215], v[214:215], v[30:31]
    s_waitcnt vmcnt(12)
    buffer_load_dwordx4 a[216:219], v1, s[12:15], s18 offen offset:2048
    v_lshlrev_b32 v216, 16, v108
    v_and_b32 v217, 0xffff0000, v108
    v_lshlrev_b32 v218, 16, v109
    v_and_b32 v219, 0xffff0000, v109
    v_lshlrev_b32 v220, 16, v110
    v_and_b32 v221, 0xffff0000, v110
    v_lshlrev_b32 v222, 16, v111
    v_and_b32 v223, 0xffff0000, v111
    buffer_load_dwordx4 a[220:223], v1, s[12:15], s18 offen offset:3072
    v_pk_add_f32 v[16:17], v[16:17], v[216:217]
    v_pk_fma_f32 v[24:25], v[216:217], v[216:217], v[24:25]
    v_pk_add_f32 v[18:19], v[18:19], v[218:219]
    v_pk_fma_f32 v[26:27], v[218:219], v[218:219], v[26:27]
    v_pk_add_f32 v[20:21], v[20:21], v[220:221]
    v_pk_fma_f32 v[28:29], v[220:221], v[220:221], v[28:29]
    v_pk_add_f32 v[22:23], v[22:23], v[222:223]
    v_pk_fma_f32 v[30:31], v[222:223], v[222:223], v[30:31]
    s_waitcnt vmcnt(13)
    buffer_load_dwordx4 a[224:227], v12, s[12:15], s40 offen offset:0
    v_lshlrev_b32 v224, 16, v112
    v_and_b32 v225, 0xffff0000, v112
    v_lshlrev_b32 v226, 16, v113
    v_and_b32 v227, 0xffff0000, v113
    v_lshlrev_b32 v228, 16, v114
    v_and_b32 v229, 0xffff0000, v114
    v_lshlrev_b32 v230, 16, v115
    v_and_b32 v231, 0xffff0000, v115
    buffer_load_dwordx4 a[228:231], v13, s[12:15], s40 offen offset:0
    v_pk_add_f32 v[16:17], v[16:17], v[224:225]
    v_pk_fma_f32 v[24:25], v[224:225], v[224:225], v[24:25]
    v_pk_add_f32 v[18:19], v[18:19], v[226:227]
    v_pk_fma_f32 v[26:27], v[226:227], v[226:227], v[26:27]
    v_pk_add_f32 v[20:21], v[20:21], v[228:229]
    v_pk_fma_f32 v[28:29], v[228:229], v[228:229], v[28:29]
    v_pk_add_f32 v[22:23], v[22:23], v[230:231]
    v_pk_fma_f32 v[30:31], v[230:231], v[230:231], v[30:31]
    s_waitcnt vmcnt(14)
    buffer_load_dwordx4 a[232:235], v12, s[12:15], s40 offen offset:2048
    v_lshlrev_b32 v232, 16, v116
    v_and_b32 v233, 0xffff0000, v116
    v_lshlrev_b32 v234, 16, v117
    v_and_b32 v235, 0xffff0000, v117
    v_lshlrev_b32 v236, 16, v118
    v_and_b32 v237, 0xffff0000, v118
    v_lshlrev_b32 v238, 16, v119
    v_and_b32 v239, 0xffff0000, v119
    buffer_load_dwordx4 a[236:239], v13, s[12:15], s40 offen offset:2048
    v_pk_add_f32 v[16:17], v[16:17], v[232:233]
    v_pk_fma_f32 v[24:25], v[232:233], v[232:233], v[24:25]
    v_pk_add_f32 v[18:19], v[18:19], v[234:235]
    v_pk_fma_f32 v[26:27], v[234:235], v[234:235], v[26:27]
    v_pk_add_f32 v[20:21], v[20:21], v[236:237]
    v_pk_fma_f32 v[28:29], v[236:237], v[236:237], v[28:29]
    v_pk_add_f32 v[22:23], v[22:23], v[238:239]
    v_pk_fma_f32 v[30:31], v[238:239], v[238:239], v[30:31]
    v_permlane32_swap_b32 v16, v24
    v_permlane32_swap_b32 v17, v25
    v_permlane32_swap_b32 v18, v26
    v_permlane32_swap_b32 v19, v27
    v_permlane32_swap_b32 v20, v28
    v_permlane32_swap_b32 v21, v29
    v_permlane32_swap_b32 v22, v30
    v_permlane32_swap_b32 v23, v31
    v_add_f32 v16, v16, v24
    v_add_f32 v17, v17, v25
    v_add_f32 v18, v18, v26
    v_add_f32 v19, v19, v27
    v_add_f32 v20, v20, v28
    v_add_f32 v21, v21, v29
    v_add_f32 v22, v22, v30
    v_add_f32 v23, v23, v31
    v_permlane16_swap_b32 v16, v17
    v_permlane16_swap_b32 v18, v19
    v_permlane16_swap_b32 v20, v21
    v_permlane16_swap_b32 v22, v23
    v_add_f32 v16, v16, v17
    v_add_f32 v18, v18, v19
    v_add_f32 v20, v20, v21
    v_add_f32 v22, v22, v23
    v_lshlrev_b32 v10, 8, v10
    v_lshl_add_u32 v10, v6, 5, v10
    v_bfe_u32 v11, v0, 4, 1
    v_lshl_add_u32 v10, v11, 2, v10
    s_lshl_b32 s23, s6, 9
    s_add_u32 s24, s23, 65536
    v_add_u32 v10, s24, v10
    v_add_f32_dpp v16, v16, v16 row_ror:8 row_mask:0xf bank_mask:0xf
    v_add_f32_dpp v18, v18, v18 row_ror:8 row_mask:0xf bank_mask:0xf
    v_add_f32_dpp v20, v20, v20 row_ror:8 row_mask:0xf bank_mask:0xf
    v_add_f32_dpp v22, v22, v22 row_ror:8 row_mask:0xf bank_mask:0xf
    ds_write2_b32 v10, v16, v18 offset0:0 offset1:2
    ds_write2_b32 v10, v20, v22 offset0:4 offset1:6
    s_waitcnt vmcnt(14)
    ds_write_b128 v9, v[120:123] offset:57344
    ds_write_b128 v9, v[124:127] offset:61440
    v_lshrrev_b32 v11, 2, v1
    v_add_u32 v60, 65536, v11
    s_waitcnt lgkmcnt(0)
    s_barrier
    ds_read2st64_b32 v[16:17], v60 offset0:0 offset1:1
    ds_read2st64_b32 v[18:19], v60 offset0:2 offset1:3
    ds_read2st64_b32 v[20:21], v60 offset0:4 offset1:5
    ds_read2st64_b32 v[22:23], v60 offset0:6 offset1:7
    s_add_u32 s24, s23, 67584
    v_add_u32 v11, s24, v11
    v_lshl_add_u32 v61, v6, 5, s24
    s_add_u32 s40, s40, 4096
    buffer_load_dwordx4 a[240:243], v12, s[12:15], s40 offen offset:0
    buffer_load_dwordx4 a[244:247], v13, s[12:15], s40 offen offset:0
    s_waitcnt lgkmcnt(0)
    v_pk_add_f32 v[16:17], v[16:17], v[18:19]
    v_pk_add_f32 v[20:21], v[20:21], v[22:23]
    v_pk_add_f32 v[16:17], v[16:17], v[20:21]
    v_mul_f32 v16, 991054117, v16
    v_mul_f32 v17, 991054117, v17
    v_fma_f32 v17, -v16, v16, v17
    v_max_f32 v17, 0, v17
    v_cvt_pk_bf16_f32 v17, 0, v17
    v_add_f32 v17, 925353388, v17
    v_cvt_pk_bf16_f32 v17, 0, v17
    v_sqrt_f32 v17, v17
    v_cvt_pk_bf16_f32 v16, 0, v16
    v_cvt_pk_bf16_f32 v17, 0, v17
    v_rcp_f32 v17, v17
    v_sub_f32 v16, 0, v16
    v_mul_f32 v16, v16, v17
    ds_write2st64_b32 v11, v17, v16 offset0:0 offset1:1
    buffer_load_dwordx4 a[248:251], v12, s[12:15], s40 offen offset:2048
    s_waitcnt lgkmcnt(0)
    ds_read_b128 v[16:19], v61
    ds_read_b128 v[20:23], v61 offset:16
    ds_read_b128 v[24:27], v61 offset:256
    ds_read_b128 v[28:31], v61 offset:272
    buffer_load_dwordx4 a[252:255], v13, s[12:15], s40 offen offset:2048
    s_waitcnt vmcnt(11) lgkmcnt(0)
    v_pk_fma_f32 v[128:129], v[128:129], v[16:17], v[24:25]
    v_pk_fma_f32 v[130:131], v[130:131], v[18:19], v[26:27]
    v_pk_fma_f32 v[132:133], v[132:133], v[20:21], v[28:29]
    v_pk_fma_f32 v[134:135], v[134:135], v[22:23], v[30:31]
    v_pk_fma_f32 v[128:129], v[128:129], v[32:33], v[32:33] op_sel:[0,0,1] op_sel_hi:[1,0,1]
    v_pk_fma_f32 v[130:131], v[130:131], v[32:33], v[32:33] op_sel:[0,0,1] op_sel_hi:[1,0,1]
    v_pk_fma_f32 v[132:133], v[132:133], v[32:33], v[32:33] op_sel:[0,0,1] op_sel_hi:[1,0,1]
    v_pk_fma_f32 v[134:135], v[134:135], v[32:33], v[32:33] op_sel:[0,0,1] op_sel_hi:[1,0,1]
    v_cvt_pk_bf16_f32 v64, v128, v129
    v_cvt_pk_bf16_f32 v65, v130, v131
    v_cvt_pk_bf16_f32 v66, v132, v133
    v_cvt_pk_bf16_f32 v67, v134, v135
    ds_write_b128 v9, v[64:67] offset:0
    v_pk_fma_f32 v[136:137], v[136:137], v[16:17], v[24:25]
    v_pk_fma_f32 v[138:139], v[138:139], v[18:19], v[26:27]
    v_pk_fma_f32 v[140:141], v[140:141], v[20:21], v[28:29]
    v_pk_fma_f32 v[142:143], v[142:143], v[22:23], v[30:31]
    v_pk_fma_f32 v[136:137], v[136:137], v[34:35], v[34:35] op_sel:[0,0,1] op_sel_hi:[1,0,1]
    v_pk_fma_f32 v[138:139], v[138:139], v[34:35], v[34:35] op_sel:[0,0,1] op_sel_hi:[1,0,1]
    v_pk_fma_f32 v[140:141], v[140:141], v[34:35], v[34:35] op_sel:[0,0,1] op_sel_hi:[1,0,1]
    v_pk_fma_f32 v[142:143], v[142:143], v[34:35], v[34:35] op_sel:[0,0,1] op_sel_hi:[1,0,1]
    v_cvt_pk_bf16_f32 v68, v136, v137
    v_cvt_pk_bf16_f32 v69, v138, v139
    v_cvt_pk_bf16_f32 v70, v140, v141
    v_cvt_pk_bf16_f32 v71, v142, v143
    ds_write_b128 v9, v[68:71] offset:4096
    v_pk_fma_f32 v[144:145], v[144:145], v[16:17], v[24:25]
    v_pk_fma_f32 v[146:147], v[146:147], v[18:19], v[26:27]
    v_pk_fma_f32 v[148:149], v[148:149], v[20:21], v[28:29]
    v_pk_fma_f32 v[150:151], v[150:151], v[22:23], v[30:31]
    v_pk_fma_f32 v[144:145], v[144:145], v[36:37], v[36:37] op_sel:[0,0,1] op_sel_hi:[1,0,1]
    v_pk_fma_f32 v[146:147], v[146:147], v[36:37], v[36:37] op_sel:[0,0,1] op_sel_hi:[1,0,1]
    v_pk_fma_f32 v[148:149], v[148:149], v[36:37], v[36:37] op_sel:[0,0,1] op_sel_hi:[1,0,1]
    v_pk_fma_f32 v[150:151], v[150:151], v[36:37], v[36:37] op_sel:[0,0,1] op_sel_hi:[1,0,1]
    v_cvt_pk_bf16_f32 v72, v144, v145
    v_cvt_pk_bf16_f32 v73, v146, v147
    v_cvt_pk_bf16_f32 v74, v148, v149
    v_cvt_pk_bf16_f32 v75, v150, v151
    ds_write_b128 v9, v[72:75] offset:8192
    v_pk_fma_f32 v[152:153], v[152:153], v[16:17], v[24:25]
    v_pk_fma_f32 v[154:155], v[154:155], v[18:19], v[26:27]
    v_pk_fma_f32 v[156:157], v[156:157], v[20:21], v[28:29]
    v_pk_fma_f32 v[158:159], v[158:159], v[22:23], v[30:31]
    v_pk_fma_f32 v[152:153], v[152:153], v[38:39], v[38:39] op_sel:[0,0,1] op_sel_hi:[1,0,1]
    v_pk_fma_f32 v[154:155], v[154:155], v[38:39], v[38:39] op_sel:[0,0,1] op_sel_hi:[1,0,1]
    v_pk_fma_f32 v[156:157], v[156:157], v[38:39], v[38:39] op_sel:[0,0,1] op_sel_hi:[1,0,1]
    v_pk_fma_f32 v[158:159], v[158:159], v[38:39], v[38:39] op_sel:[0,0,1] op_sel_hi:[1,0,1]
    v_cvt_pk_bf16_f32 v76, v152, v153
    v_cvt_pk_bf16_f32 v77, v154, v155
    v_cvt_pk_bf16_f32 v78, v156, v157
    v_cvt_pk_bf16_f32 v79, v158, v159
    ds_write_b128 v9, v[76:79] offset:12288
    v_pk_fma_f32 v[160:161], v[160:161], v[16:17], v[24:25]
    v_pk_fma_f32 v[162:163], v[162:163], v[18:19], v[26:27]
    v_pk_fma_f32 v[164:165], v[164:165], v[20:21], v[28:29]
    v_pk_fma_f32 v[166:167], v[166:167], v[22:23], v[30:31]
    v_pk_fma_f32 v[160:161], v[160:161], v[40:41], v[40:41] op_sel:[0,0,1] op_sel_hi:[1,0,1]
    v_pk_fma_f32 v[162:163], v[162:163], v[40:41], v[40:41] op_sel:[0,0,1] op_sel_hi:[1,0,1]
    v_pk_fma_f32 v[164:165], v[164:165], v[40:41], v[40:41] op_sel:[0,0,1] op_sel_hi:[1,0,1]
    v_pk_fma_f32 v[166:167], v[166:167], v[40:41], v[40:41] op_sel:[0,0,1] op_sel_hi:[1,0,1]
    v_cvt_pk_bf16_f32 v80, v160, v161
    v_cvt_pk_bf16_f32 v81, v162, v163
    v_cvt_pk_bf16_f32 v82, v164, v165
    v_cvt_pk_bf16_f32 v83, v166, v167
    ds_write_b128 v9, v[80:83] offset:16384
    v_pk_fma_f32 v[168:169], v[168:169], v[16:17], v[24:25]
    v_pk_fma_f32 v[170:171], v[170:171], v[18:19], v[26:27]
    v_pk_fma_f32 v[172:173], v[172:173], v[20:21], v[28:29]
    v_pk_fma_f32 v[174:175], v[174:175], v[22:23], v[30:31]
    v_pk_fma_f32 v[168:169], v[168:169], v[42:43], v[42:43] op_sel:[0,0,1] op_sel_hi:[1,0,1]
    v_pk_fma_f32 v[170:171], v[170:171], v[42:43], v[42:43] op_sel:[0,0,1] op_sel_hi:[1,0,1]
    v_pk_fma_f32 v[172:173], v[172:173], v[42:43], v[42:43] op_sel:[0,0,1] op_sel_hi:[1,0,1]
    v_pk_fma_f32 v[174:175], v[174:175], v[42:43], v[42:43] op_sel:[0,0,1] op_sel_hi:[1,0,1]
    v_cvt_pk_bf16_f32 v84, v168, v169
    v_cvt_pk_bf16_f32 v85, v170, v171
    v_cvt_pk_bf16_f32 v86, v172, v173
    v_cvt_pk_bf16_f32 v87, v174, v175
    ds_write_b128 v9, v[84:87] offset:20480
    v_pk_fma_f32 v[176:177], v[176:177], v[16:17], v[24:25]
    v_pk_fma_f32 v[178:179], v[178:179], v[18:19], v[26:27]
    v_pk_fma_f32 v[180:181], v[180:181], v[20:21], v[28:29]
    v_pk_fma_f32 v[182:183], v[182:183], v[22:23], v[30:31]
    v_pk_fma_f32 v[176:177], v[176:177], v[44:45], v[44:45] op_sel:[0,0,1] op_sel_hi:[1,0,1]
    v_pk_fma_f32 v[178:179], v[178:179], v[44:45], v[44:45] op_sel:[0,0,1] op_sel_hi:[1,0,1]
    v_pk_fma_f32 v[180:181], v[180:181], v[44:45], v[44:45] op_sel:[0,0,1] op_sel_hi:[1,0,1]
    v_pk_fma_f32 v[182:183], v[182:183], v[44:45], v[44:45] op_sel:[0,0,1] op_sel_hi:[1,0,1]
    v_cvt_pk_bf16_f32 v88, v176, v177
    v_cvt_pk_bf16_f32 v89, v178, v179
    v_cvt_pk_bf16_f32 v90, v180, v181
    v_cvt_pk_bf16_f32 v91, v182, v183
    ds_write_b128 v9, v[88:91] offset:24576
    v_pk_fma_f32 v[184:185], v[184:185], v[16:17], v[24:25]
    v_pk_fma_f32 v[186:187], v[186:187], v[18:19], v[26:27]
    v_pk_fma_f32 v[188:189], v[188:189], v[20:21], v[28:29]
    v_pk_fma_f32 v[190:191], v[190:191], v[22:23], v[30:31]
    v_pk_fma_f32 v[184:185], v[184:185], v[46:47], v[46:47] op_sel:[0,0,1] op_sel_hi:[1,0,1]
    v_pk_fma_f32 v[186:187], v[186:187], v[46:47], v[46:47] op_sel:[0,0,1] op_sel_hi:[1,0,1]
    v_pk_fma_f32 v[188:189], v[188:189], v[46:47], v[46:47] op_sel:[0,0,1] op_sel_hi:[1,0,1]
    v_pk_fma_f32 v[190:191], v[190:191], v[46:47], v[46:47] op_sel:[0,0,1] op_sel_hi:[1,0,1]
    v_cvt_pk_bf16_f32 v92, v184, v185
    v_cvt_pk_bf16_f32 v93, v186, v187
    v_cvt_pk_bf16_f32 v94, v188, v189
    v_cvt_pk_bf16_f32 v95, v190, v191
    ds_write_b128 v9, v[92:95] offset:28672
    v_pk_fma_f32 v[192:193], v[192:193], v[16:17], v[24:25]
    v_pk_fma_f32 v[194:195], v[194:195], v[18:19], v[26:27]
    v_pk_fma_f32 v[196:197], v[196:197], v[20:21], v[28:29]
    v_pk_fma_f32 v[198:199], v[198:199], v[22:23], v[30:31]
    v_pk_fma_f32 v[192:193], v[192:193], v[48:49], v[48:49] op_sel:[0,0,1] op_sel_hi:[1,0,1]
    v_pk_fma_f32 v[194:195], v[194:195], v[48:49], v[48:49] op_sel:[0,0,1] op_sel_hi:[1,0,1]
    v_pk_fma_f32 v[196:197], v[196:197], v[48:49], v[48:49] op_sel:[0,0,1] op_sel_hi:[1,0,1]
    v_pk_fma_f32 v[198:199], v[198:199], v[48:49], v[48:49] op_sel:[0,0,1] op_sel_hi:[1,0,1]
    v_cvt_pk_bf16_f32 v96, v192, v193
    v_cvt_pk_bf16_f32 v97, v194, v195
    v_cvt_pk_bf16_f32 v98, v196, v197
    v_cvt_pk_bf16_f32 v99, v198, v199
    ds_write_b128 v9, v[96:99] offset:32768
    v_pk_fma_f32 v[200:201], v[200:201], v[16:17], v[24:25]
    v_pk_fma_f32 v[202:203], v[202:203], v[18:19], v[26:27]
    v_pk_fma_f32 v[204:205], v[204:205], v[20:21], v[28:29]
    v_pk_fma_f32 v[206:207], v[206:207], v[22:23], v[30:31]
    v_pk_fma_f32 v[200:201], v[200:201], v[50:51], v[50:51] op_sel:[0,0,1] op_sel_hi:[1,0,1]
    v_pk_fma_f32 v[202:203], v[202:203], v[50:51], v[50:51] op_sel:[0,0,1] op_sel_hi:[1,0,1]
    v_pk_fma_f32 v[204:205], v[204:205], v[50:51], v[50:51] op_sel:[0,0,1] op_sel_hi:[1,0,1]
    v_pk_fma_f32 v[206:207], v[206:207], v[50:51], v[50:51] op_sel:[0,0,1] op_sel_hi:[1,0,1]
    v_cvt_pk_bf16_f32 v100, v200, v201
    v_cvt_pk_bf16_f32 v101, v202, v203
    v_cvt_pk_bf16_f32 v102, v204, v205
    v_cvt_pk_bf16_f32 v103, v206, v207
    ds_write_b128 v9, v[100:103] offset:36864
    v_pk_fma_f32 v[208:209], v[208:209], v[16:17], v[24:25]
    v_pk_fma_f32 v[210:211], v[210:211], v[18:19], v[26:27]
    v_pk_fma_f32 v[212:213], v[212:213], v[20:21], v[28:29]
    v_pk_fma_f32 v[214:215], v[214:215], v[22:23], v[30:31]
    v_pk_fma_f32 v[208:209], v[208:209], v[52:53], v[52:53] op_sel:[0,0,1] op_sel_hi:[1,0,1]
    v_pk_fma_f32 v[210:211], v[210:211], v[52:53], v[52:53] op_sel:[0,0,1] op_sel_hi:[1,0,1]
    v_pk_fma_f32 v[212:213], v[212:213], v[52:53], v[52:53] op_sel:[0,0,1] op_sel_hi:[1,0,1]
    v_pk_fma_f32 v[214:215], v[214:215], v[52:53], v[52:53] op_sel:[0,0,1] op_sel_hi:[1,0,1]
    v_cvt_pk_bf16_f32 v104, v208, v209
    v_cvt_pk_bf16_f32 v105, v210, v211
    v_cvt_pk_bf16_f32 v106, v212, v213
    v_cvt_pk_bf16_f32 v107, v214, v215
    ds_write_b128 v9, v[104:107] offset:40960
    v_pk_fma_f32 v[216:217], v[216:217], v[16:17], v[24:25]
    v_pk_fma_f32 v[218:219], v[218:219], v[18:19], v[26:27]
    v_pk_fma_f32 v[220:221], v[220:221], v[20:21], v[28:29]
    v_pk_fma_f32 v[222:223], v[222:223], v[22:23], v[30:31]
    v_pk_fma_f32 v[216:217], v[216:217], v[54:55], v[54:55] op_sel:[0,0,1] op_sel_hi:[1,0,1]
    v_pk_fma_f32 v[218:219], v[218:219], v[54:55], v[54:55] op_sel:[0,0,1] op_sel_hi:[1,0,1]
    v_pk_fma_f32 v[220:221], v[220:221], v[54:55], v[54:55] op_sel:[0,0,1] op_sel_hi:[1,0,1]
    v_pk_fma_f32 v[222:223], v[222:223], v[54:55], v[54:55] op_sel:[0,0,1] op_sel_hi:[1,0,1]
    v_cvt_pk_bf16_f32 v108, v216, v217
    v_cvt_pk_bf16_f32 v109, v218, v219
    v_cvt_pk_bf16_f32 v110, v220, v221
    v_cvt_pk_bf16_f32 v111, v222, v223
    ds_write_b128 v9, v[108:111] offset:45056
    v_pk_fma_f32 v[224:225], v[224:225], v[16:17], v[24:25]
    v_pk_fma_f32 v[226:227], v[226:227], v[18:19], v[26:27]
    v_pk_fma_f32 v[228:229], v[228:229], v[20:21], v[28:29]
    v_pk_fma_f32 v[230:231], v[230:231], v[22:23], v[30:31]
    v_pk_fma_f32 v[224:225], v[224:225], v[56:57], v[56:57] op_sel:[0,0,1] op_sel_hi:[1,0,1]
    v_pk_fma_f32 v[226:227], v[226:227], v[56:57], v[56:57] op_sel:[0,0,1] op_sel_hi:[1,0,1]
    v_pk_fma_f32 v[228:229], v[228:229], v[56:57], v[56:57] op_sel:[0,0,1] op_sel_hi:[1,0,1]
    v_pk_fma_f32 v[230:231], v[230:231], v[56:57], v[56:57] op_sel:[0,0,1] op_sel_hi:[1,0,1]
    v_cvt_pk_bf16_f32 v112, v224, v225
    v_cvt_pk_bf16_f32 v113, v226, v227
    v_cvt_pk_bf16_f32 v114, v228, v229
    v_cvt_pk_bf16_f32 v115, v230, v231
    ds_write_b128 v9, v[112:115] offset:49152
    v_pk_fma_f32 v[232:233], v[232:233], v[16:17], v[24:25]
    v_pk_fma_f32 v[234:235], v[234:235], v[18:19], v[26:27]
    v_pk_fma_f32 v[236:237], v[236:237], v[20:21], v[28:29]
    v_pk_fma_f32 v[238:239], v[238:239], v[22:23], v[30:31]
    v_pk_fma_f32 v[232:233], v[232:233], v[58:59], v[58:59] op_sel:[0,0,1] op_sel_hi:[1,0,1]
    v_pk_fma_f32 v[234:235], v[234:235], v[58:59], v[58:59] op_sel:[0,0,1] op_sel_hi:[1,0,1]
    v_pk_fma_f32 v[236:237], v[236:237], v[58:59], v[58:59] op_sel:[0,0,1] op_sel_hi:[1,0,1]
    v_pk_fma_f32 v[238:239], v[238:239], v[58:59], v[58:59] op_sel:[0,0,1] op_sel_hi:[1,0,1]
    v_cvt_pk_bf16_f32 v116, v232, v233
    v_cvt_pk_bf16_f32 v117, v234, v235
    v_cvt_pk_bf16_f32 v118, v236, v237
    v_cvt_pk_bf16_f32 v119, v238, v239
    ds_write_b128 v9, v[116:119] offset:53248
    s_mov_b32 s26, s50
    s_add_u32 s27, s50, 4096
    s_lshl_b32 s28, s4, 2
    s_add_u32 s28, s28, s6
    s_lshl_b32 s28, s28, 6
    s_add_u32 s28, s28, 2228224
    s_lshl_b32 s29, s5, 2
    s_add_u32 s29, s29, s28
    s_waitcnt lgkmcnt(0)
    s_barrier
    ds_read_b64_tr_b16 v[16:17], v2 offset:0
    ds_read_b64_tr_b16 v[18:19], v2 offset:512
    ds_read_b64_tr_b16 v[20:21], v2 offset:2048
    ds_read_b64_tr_b16 v[22:23], v2 offset:2560
    ds_read_b64_tr_b16 v[24:25], v2 offset:4096
    ds_read_b64_tr_b16 v[26:27], v2 offset:4608
    s_waitcnt lgkmcnt(4)
    v_mfma_f32_32x32x16_bf16 v[64:79], a[0:3], v[16:19], 0
    ds_read_b64_tr_b16 v[28:29], v2 offset:6144
    ds_read_b64_tr_b16 v[30:31], v2 offset:6656
    v_mfma_f32_32x32x16_bf16 v[80:95], a[4:7], v[16:19], 0
    buffer_load_dwordx4 v[128:131], v12, s[12:15], s41 offen offset:0
    s_waitcnt lgkmcnt(4)
    v_mfma_f32_32x32x16_bf16 v[64:79], a[8:11], v[20:23], v[64:79]
    ds_read_b64_tr_b16 v[16:17], v2 offset:8192
    ds_read_b64_tr_b16 v[18:19], v2 offset:8704
    v_mfma_f32_32x32x16_bf16 v[80:95], a[12:15], v[20:23], v[80:95]
    buffer_load_dwordx4 v[132:135], v13, s[12:15], s41 offen offset:0
    s_waitcnt lgkmcnt(4)
    v_mfma_f32_32x32x16_bf16 v[64:79], a[16:19], v[24:27], v[64:79]
    ds_read_b64_tr_b16 v[20:21], v2 offset:10240
    ds_read_b64_tr_b16 v[22:23], v2 offset:10752
    v_mfma_f32_32x32x16_bf16 v[80:95], a[20:23], v[24:27], v[80:95]
    buffer_load_dwordx4 v[136:139], v12, s[12:15], s41 offen offset:2048
    s_waitcnt lgkmcnt(4)
    v_mfma_f32_32x32x16_bf16 v[64:79], a[24:27], v[28:31], v[64:79]
    ds_read_b64_tr_b16 v[24:25], v2 offset:12288
    ds_read_b64_tr_b16 v[26:27], v2 offset:12800
    v_mfma_f32_32x32x16_bf16 v[80:95], a[28:31], v[28:31], v[80:95]
    buffer_load_dwordx4 v[140:143], v13, s[12:15], s41 offen offset:2048
    s_waitcnt lgkmcnt(4)
    v_mfma_f32_32x32x16_bf16 v[64:79], a[32:35], v[16:19], v[64:79]
    ds_read_b64_tr_b16 v[28:29], v2 offset:14336
    ds_read_b64_tr_b16 v[30:31], v2 offset:14848
    v_mfma_f32_32x32x16_bf16 v[80:95], a[36:39], v[16:19], v[80:95]
    s_add_u32 s41, s41, 4096
    buffer_load_dwordx4 v[144:147], v12, s[12:15], s41 offen offset:0
    s_waitcnt lgkmcnt(4)
    v_mfma_f32_32x32x16_bf16 v[64:79], a[40:43], v[20:23], v[64:79]
    ds_read_b64_tr_b16 v[16:17], v2 offset:16384
    ds_read_b64_tr_b16 v[18:19], v2 offset:16896
    v_mfma_f32_32x32x16_bf16 v[80:95], a[44:47], v[20:23], v[80:95]
    buffer_load_dwordx4 v[148:151], v13, s[12:15], s41 offen offset:0
    s_waitcnt lgkmcnt(4)
    v_mfma_f32_32x32x16_bf16 v[64:79], a[48:51], v[24:27], v[64:79]
    ds_read_b64_tr_b16 v[20:21], v2 offset:18432
    ds_read_b64_tr_b16 v[22:23], v2 offset:18944
    v_mfma_f32_32x32x16_bf16 v[80:95], a[52:55], v[24:27], v[80:95]
    buffer_load_dwordx4 v[152:155], v12, s[12:15], s41 offen offset:2048
    s_waitcnt lgkmcnt(4)
    v_mfma_f32_32x32x16_bf16 v[64:79], a[56:59], v[28:31], v[64:79]
    ds_read_b64_tr_b16 v[24:25], v2 offset:20480
    ds_read_b64_tr_b16 v[26:27], v2 offset:20992
    v_mfma_f32_32x32x16_bf16 v[80:95], a[60:63], v[28:31], v[80:95]
    buffer_load_dwordx4 v[156:159], v13, s[12:15], s41 offen offset:2048
    s_waitcnt lgkmcnt(4)
    v_mfma_f32_32x32x16_bf16 v[64:79], a[64:67], v[16:19], v[64:79]
    ds_read_b64_tr_b16 v[28:29], v2 offset:22528
    ds_read_b64_tr_b16 v[30:31], v2 offset:23040
    v_mfma_f32_32x32x16_bf16 v[80:95], a[68:71], v[16:19], v[80:95]
    buffer_load_dwordx4 v[160:163], v12, s[12:15], s42 offen offset:0
    s_waitcnt lgkmcnt(4)
    v_mfma_f32_32x32x16_bf16 v[64:79], a[72:75], v[20:23], v[64:79]
    ds_read_b64_tr_b16 v[16:17], v2 offset:24576
    ds_read_b64_tr_b16 v[18:19], v2 offset:25088
    v_mfma_f32_32x32x16_bf16 v[80:95], a[76:79], v[20:23], v[80:95]
    buffer_load_dwordx4 v[164:167], v13, s[12:15], s42 offen offset:0
    s_waitcnt lgkmcnt(4)
    v_mfma_f32_32x32x16_bf16 v[64:79], a[80:83], v[24:27], v[64:79]
    ds_read_b64_tr_b16 v[20:21], v2 offset:26624
    ds_read_b64_tr_b16 v[22:23], v2 offset:27136
    v_mfma_f32_32x32x16_bf16 v[80:95], a[84:87], v[24:27], v[80:95]
    buffer_load_dwordx4 v[168:171], v12, s[12:15], s42 offen offset:2048
    s_waitcnt lgkmcnt(4)
    v_mfma_f32_32x32x16_bf16 v[64:79], a[88:91], v[28:31], v[64:79]
    ds_read_b64_tr_b16 v[24:25], v2 offset:28672
    ds_read_b64_tr_b16 v[26:27], v2 offset:29184
    v_mfma_f32_32x32x16_bf16 v[80:95], a[92:95], v[28:31], v[80:95]
    buffer_load_dwordx4 v[172:175], v13, s[12:15], s42 offen offset:2048
    s_waitcnt lgkmcnt(4)
    v_mfma_f32_32x32x16_bf16 v[64:79], a[96:99], v[16:19], v[64:79]
    ds_read_b64_tr_b16 v[28:29], v2 offset:30720
    ds_read_b64_tr_b16 v[30:31], v2 offset:31232
    v_mfma_f32_32x32x16_bf16 v[80:95], a[100:103], v[16:19], v[80:95]
    s_add_u32 s42, s42, 4096
    buffer_load_dwordx4 v[176:179], v12, s[12:15], s42 offen offset:0
    s_waitcnt lgkmcnt(4)
    v_mfma_f32_32x32x16_bf16 v[64:79], a[104:107], v[20:23], v[64:79]
    ds_read_b64_tr_b16 v[16:17], v2 offset:32768
    ds_read_b64_tr_b16 v[18:19], v2 offset:33280
    v_mfma_f32_32x32x16_bf16 v[80:95], a[108:111], v[20:23], v[80:95]
    buffer_load_dwordx4 v[180:183], v13, s[12:15], s42 offen offset:0
    s_waitcnt lgkmcnt(4)
    v_mfma_f32_32x32x16_bf16 v[64:79], a[112:115], v[24:27], v[64:79]
    ds_read_b64_tr_b16 v[20:21], v2 offset:34816
    ds_read_b64_tr_b16 v[22:23], v2 offset:35328
    v_mfma_f32_32x32x16_bf16 v[80:95], a[116:119], v[24:27], v[80:95]
    buffer_load_dwordx4 v[184:187], v12, s[12:15], s42 offen offset:2048
    s_waitcnt lgkmcnt(4)
    v_mfma_f32_32x32x16_bf16 v[64:79], a[120:123], v[28:31], v[64:79]
    ds_read_b64_tr_b16 v[24:25], v2 offset:36864
    ds_read_b64_tr_b16 v[26:27], v2 offset:37376
    v_mfma_f32_32x32x16_bf16 v[80:95], a[124:127], v[28:31], v[80:95]
    buffer_load_dwordx4 v[188:191], v13, s[12:15], s42 offen offset:2048
    s_waitcnt lgkmcnt(4)
    v_mfma_f32_32x32x16_bf16 v[64:79], a[128:131], v[16:19], v[64:79]
    ds_read_b64_tr_b16 v[28:29], v2 offset:38912
    ds_read_b64_tr_b16 v[30:31], v2 offset:39424
    v_mfma_f32_32x32x16_bf16 v[80:95], a[132:135], v[16:19], v[80:95]
    buffer_load_dwordx4 v[192:195], v12, s[12:15], s43 offen offset:0
    s_waitcnt lgkmcnt(4)
    v_mfma_f32_32x32x16_bf16 v[64:79], a[136:139], v[20:23], v[64:79]
    ds_read_b64_tr_b16 v[16:17], v2 offset:40960
    ds_read_b64_tr_b16 v[18:19], v2 offset:41472
    v_mfma_f32_32x32x16_bf16 v[80:95], a[140:143], v[20:23], v[80:95]
    buffer_load_dwordx4 v[196:199], v13, s[12:15], s43 offen offset:0
    s_waitcnt lgkmcnt(4)
    v_mfma_f32_32x32x16_bf16 v[64:79], a[144:147], v[24:27], v[64:79]
    ds_read_b64_tr_b16 v[20:21], v2 offset:43008
    ds_read_b64_tr_b16 v[22:23], v2 offset:43520
    v_mfma_f32_32x32x16_bf16 v[80:95], a[148:151], v[24:27], v[80:95]
    buffer_load_dwordx4 v[200:203], v12, s[12:15], s43 offen offset:2048
    s_waitcnt lgkmcnt(4)
    v_mfma_f32_32x32x16_bf16 v[64:79], a[152:155], v[28:31], v[64:79]
    ds_read_b64_tr_b16 v[24:25], v2 offset:45056
    ds_read_b64_tr_b16 v[26:27], v2 offset:45568
    v_mfma_f32_32x32x16_bf16 v[80:95], a[156:159], v[28:31], v[80:95]
    buffer_load_dwordx4 v[204:207], v13, s[12:15], s43 offen offset:2048
    s_waitcnt lgkmcnt(4)
    v_mfma_f32_32x32x16_bf16 v[64:79], a[160:163], v[16:19], v[64:79]
    ds_read_b64_tr_b16 v[28:29], v2 offset:47104
    ds_read_b64_tr_b16 v[30:31], v2 offset:47616
    v_mfma_f32_32x32x16_bf16 v[80:95], a[164:167], v[16:19], v[80:95]
    s_add_u32 s43, s43, 4096
    buffer_load_dwordx4 v[208:211], v12, s[12:15], s43 offen offset:0
    s_waitcnt lgkmcnt(4)
    v_mfma_f32_32x32x16_bf16 v[64:79], a[168:171], v[20:23], v[64:79]
    ds_read_b64_tr_b16 v[16:17], v2 offset:49152
    ds_read_b64_tr_b16 v[18:19], v2 offset:49664
    v_mfma_f32_32x32x16_bf16 v[80:95], a[172:175], v[20:23], v[80:95]
    buffer_load_dwordx4 v[212:215], v13, s[12:15], s43 offen offset:0
    s_waitcnt lgkmcnt(4)
    v_mfma_f32_32x32x16_bf16 v[64:79], a[176:179], v[24:27], v[64:79]
    ds_read_b64_tr_b16 v[20:21], v2 offset:51200
    ds_read_b64_tr_b16 v[22:23], v2 offset:51712
    v_mfma_f32_32x32x16_bf16 v[80:95], a[180:183], v[24:27], v[80:95]
    buffer_load_dwordx4 v[216:219], v12, s[12:15], s43 offen offset:2048
    s_waitcnt lgkmcnt(4)
    v_mfma_f32_32x32x16_bf16 v[64:79], a[184:187], v[28:31], v[64:79]
    ds_read_b64_tr_b16 v[24:25], v2 offset:53248
    ds_read_b64_tr_b16 v[26:27], v2 offset:53760
    v_mfma_f32_32x32x16_bf16 v[80:95], a[188:191], v[28:31], v[80:95]
    buffer_load_dwordx4 v[220:223], v13, s[12:15], s43 offen offset:2048
    s_waitcnt lgkmcnt(4)
    v_mfma_f32_32x32x16_bf16 v[64:79], a[192:195], v[16:19], v[64:79]
    ds_read_b64_tr_b16 v[28:29], v2 offset:55296
    ds_read_b64_tr_b16 v[30:31], v2 offset:55808
    v_mfma_f32_32x32x16_bf16 v[80:95], a[196:199], v[16:19], v[80:95]
    buffer_load_dwordx4 v[224:227], v12, s[12:15], s44 offen offset:0
    s_waitcnt lgkmcnt(4)
    v_mfma_f32_32x32x16_bf16 v[64:79], a[200:203], v[20:23], v[64:79]
    ds_read_b64_tr_b16 v[16:17], v3 offset:0
    ds_read_b64_tr_b16 v[18:19], v3 offset:512
    v_mfma_f32_32x32x16_bf16 v[80:95], a[204:207], v[20:23], v[80:95]
    buffer_load_dwordx4 v[228:231], v13, s[12:15], s44 offen offset:0
    s_waitcnt vmcnt(36) lgkmcnt(4)
    v_mfma_f32_32x32x16_bf16 v[64:79], a[208:211], v[24:27], v[64:79]
    ds_read_b64_tr_b16 v[20:21], v3 offset:2048
    ds_read_b64_tr_b16 v[22:23], v3 offset:2560
    v_mfma_f32_32x32x16_bf16 v[80:95], a[212:215], v[24:27], v[80:95]
    buffer_load_dwordx4 v[232:235], v12, s[12:15], s44 offen offset:2048
    s_waitcnt vmcnt(35) lgkmcnt(4)
    v_mfma_f32_32x32x16_bf16 v[64:79], a[216:219], v[28:31], v[64:79]
    ds_read_b64_tr_b16 v[24:25], v3 offset:4096
    ds_read_b64_tr_b16 v[26:27], v3 offset:4608
    v_mfma_f32_32x32x16_bf16 v[80:95], a[220:223], v[28:31], v[80:95]
    buffer_load_dwordx4 v[236:239], v13, s[12:15], s44 offen offset:2048
    s_waitcnt lgkmcnt(4)
    v_mfma_f32_32x32x16_bf16 v[96:111], a[0:3], v[16:19], 0
    ds_read_b64_tr_b16 v[28:29], v3 offset:6144
    ds_read_b64_tr_b16 v[30:31], v3 offset:6656
    v_mfma_f32_32x32x16_bf16 v[112:127], a[4:7], v[16:19], 0
    s_add_u32 s44, s44, 4096
    buffer_load_dwordx4 v[240:243], v12, s[12:15], s44 offen offset:0
    s_waitcnt lgkmcnt(4)
    v_mfma_f32_32x32x16_bf16 v[96:111], a[8:11], v[20:23], v[96:111]
    ds_read_b64_tr_b16 v[16:17], v3 offset:8192
    ds_read_b64_tr_b16 v[18:19], v3 offset:8704
    v_exp_f32 v4, -v64
    v_exp_f32 v5, -v65
    v_exp_f32 v6, -v66
    v_exp_f32 v7, -v67
    v_mfma_f32_32x32x16_bf16 v[112:127], a[12:15], v[20:23], v[112:127]
    buffer_load_dwordx4 v[244:247], v13, s[12:15], s44 offen offset:0
    v_exp_f32 v8, -v68
    v_exp_f32 v9, -v69
    v_exp_f32 v10, -v70
    v_exp_f32 v11, -v71
    s_waitcnt lgkmcnt(4)
    v_mfma_f32_32x32x16_bf16 v[96:111], a[16:19], v[24:27], v[96:111]
    ds_read_b64_tr_b16 v[20:21], v3 offset:10240
    ds_read_b64_tr_b16 v[22:23], v3 offset:10752
    v_add_f32 v4, 1.0, v4
    v_add_f32 v5, 1.0, v5
    v_add_f32 v6, 1.0, v6
    v_add_f32 v7, 1.0, v7
    v_mfma_f32_32x32x16_bf16 v[112:127], a[20:23], v[24:27], v[112:127]
    buffer_load_dwordx4 v[248:251], v12, s[12:15], s44 offen offset:2048
    v_add_f32 v8, 1.0, v8
    v_add_f32 v9, 1.0, v9
    v_add_f32 v10, 1.0, v10
    v_add_f32 v11, 1.0, v11
    s_waitcnt lgkmcnt(4)
    v_mfma_f32_32x32x16_bf16 v[96:111], a[24:27], v[28:31], v[96:111]
    ds_read_b64_tr_b16 v[24:25], v3 offset:12288
    ds_read_b64_tr_b16 v[26:27], v3 offset:12800
    v_rcp_f32 v4, v4
    v_rcp_f32 v5, v5
    v_rcp_f32 v6, v6
    v_rcp_f32 v7, v7
    v_mfma_f32_32x32x16_bf16 v[112:127], a[28:31], v[28:31], v[112:127]
    buffer_load_dwordx4 v[252:255], v13, s[12:15], s44 offen offset:2048
    v_rcp_f32 v8, v8
    v_rcp_f32 v9, v9
    v_rcp_f32 v10, v10
    v_rcp_f32 v11, v11
    s_waitcnt lgkmcnt(4)
    v_mfma_f32_32x32x16_bf16 v[96:111], a[32:35], v[16:19], v[96:111]
    ds_read_b64_tr_b16 v[28:29], v3 offset:14336
    ds_read_b64_tr_b16 v[30:31], v3 offset:14848
    v_mul_f32 v4, v64, v4
    v_mul_f32 v5, v65, v5
    v_mul_f32 v6, v66, v6
    v_mul_f32 v7, v67, v7
    v_mfma_f32_32x32x16_bf16 v[112:127], a[36:39], v[16:19], v[112:127]
    v_mul_f32 v8, v68, v8
    v_mul_f32 v9, v69, v9
    v_mul_f32 v10, v70, v10
    v_mul_f32 v11, v71, v11
    s_waitcnt lgkmcnt(4)
    v_mfma_f32_32x32x16_bf16 v[96:111], a[40:43], v[20:23], v[96:111]
    ds_read_b64_tr_b16 v[16:17], v3 offset:16384
    ds_read_b64_tr_b16 v[18:19], v3 offset:16896
    v_cvt_pk_bf16_f32 v32, v4, v5
    v_cvt_pk_bf16_f32 v33, v6, v7
    v_cvt_pk_bf16_f32 v34, v8, v9
    v_cvt_pk_bf16_f32 v35, v10, v11
    v_mfma_f32_32x32x16_bf16 v[112:127], a[44:47], v[20:23], v[112:127]
    buffer_store_dwordx4 v[32:35], v14, s[12:15], s26 offen offset:0 sc1
    v_exp_f32 v4, -v72
    v_exp_f32 v5, -v73
    v_exp_f32 v6, -v74
    s_waitcnt lgkmcnt(4)
    v_mfma_f32_32x32x16_bf16 v[96:111], a[48:51], v[24:27], v[96:111]
    ds_read_b64_tr_b16 v[20:21], v3 offset:18432
    ds_read_b64_tr_b16 v[22:23], v3 offset:18944
    v_exp_f32 v7, -v75
    v_exp_f32 v8, -v76
    v_exp_f32 v9, -v77
    v_exp_f32 v10, -v78
    v_mfma_f32_32x32x16_bf16 v[112:127], a[52:55], v[24:27], v[112:127]
    v_exp_f32 v11, -v79
    v_add_f32 v4, 1.0, v4
    v_add_f32 v5, 1.0, v5
    v_add_f32 v6, 1.0, v6
    s_waitcnt lgkmcnt(4)
    v_mfma_f32_32x32x16_bf16 v[96:111], a[56:59], v[28:31], v[96:111]
    ds_read_b64_tr_b16 v[24:25], v3 offset:20480
    ds_read_b64_tr_b16 v[26:27], v3 offset:20992
    v_add_f32 v7, 1.0, v7
    v_add_f32 v8, 1.0, v8
    v_add_f32 v9, 1.0, v9
    v_add_f32 v10, 1.0, v10
    v_mfma_f32_32x32x16_bf16 v[112:127], a[60:63], v[28:31], v[112:127]
    v_add_f32 v11, 1.0, v11
    v_rcp_f32 v4, v4
    v_rcp_f32 v5, v5
    v_rcp_f32 v6, v6
    s_waitcnt lgkmcnt(4)
    v_mfma_f32_32x32x16_bf16 v[96:111], a[64:67], v[16:19], v[96:111]
    ds_read_b64_tr_b16 v[28:29], v3 offset:22528
    ds_read_b64_tr_b16 v[30:31], v3 offset:23040
    v_rcp_f32 v7, v7
    v_rcp_f32 v8, v8
    v_rcp_f32 v9, v9
    v_rcp_f32 v10, v10
    v_mfma_f32_32x32x16_bf16 v[112:127], a[68:71], v[16:19], v[112:127]
    v_rcp_f32 v11, v11
    v_mul_f32 v4, v72, v4
    v_mul_f32 v5, v73, v5
    v_mul_f32 v6, v74, v6
    s_waitcnt lgkmcnt(4)
    v_mfma_f32_32x32x16_bf16 v[96:111], a[72:75], v[20:23], v[96:111]
    ds_read_b64_tr_b16 v[16:17], v3 offset:24576
    ds_read_b64_tr_b16 v[18:19], v3 offset:25088
    v_mul_f32 v7, v75, v7
    v_mul_f32 v8, v76, v8
    v_mul_f32 v9, v77, v9
    v_mul_f32 v10, v78, v10
    v_mfma_f32_32x32x16_bf16 v[112:127], a[76:79], v[20:23], v[112:127]
    buffer_load_dwordx4 a[0:3], v12, s[12:15], s45 offen offset:0
    v_mul_f32 v11, v79, v11
    v_cvt_pk_bf16_f32 v40, v4, v5
    v_cvt_pk_bf16_f32 v41, v6, v7
    v_cvt_pk_bf16_f32 v42, v8, v9
    s_waitcnt lgkmcnt(4)
    v_mfma_f32_32x32x16_bf16 v[96:111], a[80:83], v[24:27], v[96:111]
    ds_read_b64_tr_b16 v[20:21], v3 offset:26624
    ds_read_b64_tr_b16 v[22:23], v3 offset:27136
    v_cvt_pk_bf16_f32 v43, v10, v11
    buffer_store_dwordx4 v[40:43], v14, s[12:15], s26 offen offset:2048 sc1
    v_exp_f32 v4, -v80
    v_exp_f32 v5, -v81
    v_mfma_f32_32x32x16_bf16 v[112:127], a[84:87], v[24:27], v[112:127]
    buffer_load_dwordx4 a[4:7], v13, s[12:15], s45 offen offset:0
    v_exp_f32 v6, -v82
    v_exp_f32 v7, -v83
    v_exp_f32 v8, -v84
    v_exp_f32 v9, -v85
    s_waitcnt lgkmcnt(4)
    v_mfma_f32_32x32x16_bf16 v[96:111], a[88:91], v[28:31], v[96:111]
    ds_read_b64_tr_b16 v[24:25], v3 offset:28672
    ds_read_b64_tr_b16 v[26:27], v3 offset:29184
    v_exp_f32 v10, -v86
    v_exp_f32 v11, -v87
    v_add_f32 v4, 1.0, v4
    v_add_f32 v5, 1.0, v5
    v_mfma_f32_32x32x16_bf16 v[112:127], a[92:95], v[28:31], v[112:127]
    buffer_load_dwordx4 a[8:11], v12, s[12:15], s45 offen offset:2048
    v_add_f32 v6, 1.0, v6
    v_add_f32 v7, 1.0, v7
    v_add_f32 v8, 1.0, v8
    v_add_f32 v9, 1.0, v9
    s_waitcnt lgkmcnt(4)
    v_mfma_f32_32x32x16_bf16 v[96:111], a[96:99], v[16:19], v[96:111]
    ds_read_b64_tr_b16 v[28:29], v3 offset:30720
    ds_read_b64_tr_b16 v[30:31], v3 offset:31232
    v_add_f32 v10, 1.0, v10
    v_add_f32 v11, 1.0, v11
    v_rcp_f32 v4, v4
    v_rcp_f32 v5, v5
    v_mfma_f32_32x32x16_bf16 v[112:127], a[100:103], v[16:19], v[112:127]
    buffer_load_dwordx4 a[12:15], v13, s[12:15], s45 offen offset:2048
    v_rcp_f32 v6, v6
    v_rcp_f32 v7, v7
    v_rcp_f32 v8, v8
    v_rcp_f32 v9, v9
    s_waitcnt lgkmcnt(4)
    v_mfma_f32_32x32x16_bf16 v[96:111], a[104:107], v[20:23], v[96:111]
    ds_read_b64_tr_b16 v[16:17], v3 offset:32768
    ds_read_b64_tr_b16 v[18:19], v3 offset:33280
    v_rcp_f32 v10, v10
    v_rcp_f32 v11, v11
    v_mul_f32 v4, v80, v4
    v_mul_f32 v5, v81, v5
    v_mfma_f32_32x32x16_bf16 v[112:127], a[108:111], v[20:23], v[112:127]
    s_add_u32 s45, s45, 4096
    buffer_load_dwordx4 a[16:19], v12, s[12:15], s45 offen offset:0
    v_mul_f32 v6, v82, v6
    v_mul_f32 v7, v83, v7
    v_mul_f32 v8, v84, v8
    v_mul_f32 v9, v85, v9
    s_waitcnt lgkmcnt(4)
    v_mfma_f32_32x32x16_bf16 v[96:111], a[112:115], v[24:27], v[96:111]
    ds_read_b64_tr_b16 v[20:21], v3 offset:34816
    ds_read_b64_tr_b16 v[22:23], v3 offset:35328
    v_mul_f32 v10, v86, v10
    v_mul_f32 v11, v87, v11
    v_cvt_pk_bf16_f32 v48, v4, v5
    v_cvt_pk_bf16_f32 v49, v6, v7
    v_mfma_f32_32x32x16_bf16 v[112:127], a[116:119], v[24:27], v[112:127]
    buffer_load_dwordx4 a[20:23], v13, s[12:15], s45 offen offset:0
    v_cvt_pk_bf16_f32 v50, v8, v9
    v_cvt_pk_bf16_f32 v51, v10, v11
    buffer_store_dwordx4 v[48:51], v14, s[12:15], s27 offen offset:0 sc1
    v_exp_f32 v4, -v88
    s_waitcnt lgkmcnt(4)
    v_mfma_f32_32x32x16_bf16 v[96:111], a[120:123], v[28:31], v[96:111]
    ds_read_b64_tr_b16 v[24:25], v3 offset:36864
    ds_read_b64_tr_b16 v[26:27], v3 offset:37376
    v_exp_f32 v5, -v89
    v_exp_f32 v6, -v90
    v_exp_f32 v7, -v91
    v_exp_f32 v8, -v92
    v_mfma_f32_32x32x16_bf16 v[112:127], a[124:127], v[28:31], v[112:127]
    buffer_load_dwordx4 a[24:27], v12, s[12:15], s45 offen offset:2048
    v_exp_f32 v9, -v93
    v_exp_f32 v10, -v94
    v_exp_f32 v11, -v95
    v_add_f32 v4, 1.0, v4
    s_waitcnt lgkmcnt(4)
    v_mfma_f32_32x32x16_bf16 v[96:111], a[128:131], v[16:19], v[96:111]
    ds_read_b64_tr_b16 v[28:29], v3 offset:38912
    ds_read_b64_tr_b16 v[30:31], v3 offset:39424
    v_add_f32 v5, 1.0, v5
    v_add_f32 v6, 1.0, v6
    v_add_f32 v7, 1.0, v7
    v_add_f32 v8, 1.0, v8
    v_mfma_f32_32x32x16_bf16 v[112:127], a[132:135], v[16:19], v[112:127]
    buffer_load_dwordx4 a[28:31], v13, s[12:15], s45 offen offset:2048
    v_add_f32 v9, 1.0, v9
    v_add_f32 v10, 1.0, v10
    v_add_f32 v11, 1.0, v11
    v_rcp_f32 v4, v4
    s_waitcnt lgkmcnt(4)
    v_mfma_f32_32x32x16_bf16 v[96:111], a[136:139], v[20:23], v[96:111]
    ds_read_b64_tr_b16 v[16:17], v3 offset:40960
    ds_read_b64_tr_b16 v[18:19], v3 offset:41472
    v_rcp_f32 v5, v5
    v_rcp_f32 v6, v6
    v_rcp_f32 v7, v7
    v_rcp_f32 v8, v8
    v_mfma_f32_32x32x16_bf16 v[112:127], a[140:143], v[20:23], v[112:127]
    buffer_load_dwordx4 a[32:35], v12, s[12:15], s46 offen offset:0
    v_rcp_f32 v9, v9
    v_rcp_f32 v10, v10
    v_rcp_f32 v11, v11
    v_mul_f32 v4, v88, v4
    s_waitcnt lgkmcnt(4)
    v_mfma_f32_32x32x16_bf16 v[96:111], a[144:147], v[24:27], v[96:111]
    ds_read_b64_tr_b16 v[20:21], v3 offset:43008
    ds_read_b64_tr_b16 v[22:23], v3 offset:43520
    v_mul_f32 v5, v89, v5
    v_mul_f32 v6, v90, v6
    v_mul_f32 v7, v91, v7
    v_mul_f32 v8, v92, v8
    v_mfma_f32_32x32x16_bf16 v[112:127], a[148:151], v[24:27], v[112:127]
    buffer_load_dwordx4 a[36:39], v13, s[12:15], s46 offen offset:0
    v_mul_f32 v9, v93, v9
    v_mul_f32 v10, v94, v10
    v_mul_f32 v11, v95, v11
    v_cvt_pk_bf16_f32 v56, v4, v5
    s_waitcnt lgkmcnt(4)
    v_mfma_f32_32x32x16_bf16 v[96:111], a[152:155], v[28:31], v[96:111]
    ds_read_b64_tr_b16 v[24:25], v3 offset:45056
    ds_read_b64_tr_b16 v[26:27], v3 offset:45568
    v_cvt_pk_bf16_f32 v57, v6, v7
    v_cvt_pk_bf16_f32 v58, v8, v9
    v_cvt_pk_bf16_f32 v59, v10, v11
    buffer_store_dwordx4 v[56:59], v14, s[12:15], s27 offen offset:2048 sc1
    v_mfma_f32_32x32x16_bf16 v[112:127], a[156:159], v[28:31], v[112:127]
    buffer_load_dwordx4 a[40:43], v12, s[12:15], s46 offen offset:2048
    s_waitcnt lgkmcnt(4)
    v_mfma_f32_32x32x16_bf16 v[96:111], a[160:163], v[16:19], v[96:111]
    ds_read_b64_tr_b16 v[28:29], v3 offset:47104
    ds_read_b64_tr_b16 v[30:31], v3 offset:47616
    v_mfma_f32_32x32x16_bf16 v[112:127], a[164:167], v[16:19], v[112:127]
    buffer_load_dwordx4 a[44:47], v13, s[12:15], s46 offen offset:2048
    s_waitcnt lgkmcnt(4)
    v_mfma_f32_32x32x16_bf16 v[96:111], a[168:171], v[20:23], v[96:111]
    ds_read_b64_tr_b16 v[16:17], v3 offset:49152
    ds_read_b64_tr_b16 v[18:19], v3 offset:49664
    v_mfma_f32_32x32x16_bf16 v[112:127], a[172:175], v[20:23], v[112:127]
    s_add_u32 s46, s46, 4096
    buffer_load_dwordx4 a[48:51], v12, s[12:15], s46 offen offset:0
    s_waitcnt lgkmcnt(4)
    v_mfma_f32_32x32x16_bf16 v[96:111], a[176:179], v[24:27], v[96:111]
    ds_read_b64_tr_b16 v[20:21], v3 offset:51200
    ds_read_b64_tr_b16 v[22:23], v3 offset:51712
    v_mfma_f32_32x32x16_bf16 v[112:127], a[180:183], v[24:27], v[112:127]
    buffer_load_dwordx4 a[52:55], v13, s[12:15], s46 offen offset:0
    s_waitcnt lgkmcnt(4)
    v_mfma_f32_32x32x16_bf16 v[96:111], a[184:187], v[28:31], v[96:111]
    ds_read_b64_tr_b16 v[24:25], v3 offset:53248
    ds_read_b64_tr_b16 v[26:27], v3 offset:53760
    v_mfma_f32_32x32x16_bf16 v[112:127], a[188:191], v[28:31], v[112:127]
    buffer_load_dwordx4 a[56:59], v12, s[12:15], s46 offen offset:2048
    s_waitcnt lgkmcnt(4)
    v_mfma_f32_32x32x16_bf16 v[96:111], a[192:195], v[16:19], v[96:111]
    ds_read_b64_tr_b16 v[28:29], v3 offset:55296
    ds_read_b64_tr_b16 v[30:31], v3 offset:55808
    v_mfma_f32_32x32x16_bf16 v[112:127], a[196:199], v[16:19], v[112:127]
    buffer_load_dwordx4 a[60:63], v13, s[12:15], s46 offen offset:2048
    s_waitcnt lgkmcnt(4)
    v_mfma_f32_32x32x16_bf16 v[96:111], a[200:203], v[20:23], v[96:111]
    v_mfma_f32_32x32x16_bf16 v[112:127], a[204:207], v[20:23], v[112:127]
    s_waitcnt lgkmcnt(2)
    v_mfma_f32_32x32x16_bf16 v[96:111], a[208:211], v[24:27], v[96:111]
    v_mfma_f32_32x32x16_bf16 v[112:127], a[212:215], v[24:27], v[112:127]
    s_waitcnt lgkmcnt(0)
    v_mfma_f32_32x32x16_bf16 v[96:111], a[216:219], v[28:31], v[96:111]
    v_mfma_f32_32x32x16_bf16 v[112:127], a[220:223], v[28:31], v[112:127]
    s_add_u32 s61, s51, 4096
    s_add_u32 s62, s52, 4096
    s_add_u32 s63, s53, 4096
    s_add_u32 s64, s54, 4096
    s_add_u32 s65, s55, 4096
    s_add_u32 s66, s56, 4096
    v_lshrrev_b32 v24, 2, v1
    v_add_u32 v24, s28, v24
    s_nop 2
    v_exp_f32 v4, -v96
    v_exp_f32 v5, -v97
    v_exp_f32 v6, -v98
    v_exp_f32 v7, -v99
    v_exp_f32 v8, -v100
    v_exp_f32 v9, -v101
    v_exp_f32 v10, -v102
    v_exp_f32 v11, -v103
    s_waitcnt vmcnt(52)
    v_mfma_f32_32x32x16_bf16 v[64:79], a[224:227], v[32:35], 0
    v_add_f32 v4, 1.0, v4
    v_add_f32 v5, 1.0, v5
    v_add_f32 v6, 1.0, v6
    v_add_f32 v7, 1.0, v7
    v_add_f32 v8, 1.0, v8
    v_add_f32 v9, 1.0, v9
    v_add_f32 v10, 1.0, v10
    v_add_f32 v11, 1.0, v11
    v_rcp_f32 v4, v4
    v_rcp_f32 v5, v5
    v_rcp_f32 v6, v6
    v_rcp_f32 v7, v7
    v_rcp_f32 v8, v8
    v_rcp_f32 v9, v9
    v_rcp_f32 v10, v10
    v_rcp_f32 v11, v11
    v_mfma_f32_32x32x16_bf16 v[80:95], a[228:231], v[32:35], 0
    v_mul_f32 v4, v96, v4
    v_mul_f32 v5, v97, v5
    v_mul_f32 v6, v98, v6
    v_mul_f32 v7, v99, v7
    v_mul_f32 v8, v100, v8
    v_mul_f32 v9, v101, v9
    v_mul_f32 v10, v102, v10
    v_mul_f32 v11, v103, v11
    v_cvt_pk_bf16_f32 v36, v4, v5
    v_cvt_pk_bf16_f32 v37, v6, v7
    v_cvt_pk_bf16_f32 v38, v8, v9
    v_cvt_pk_bf16_f32 v39, v10, v11
    buffer_store_dwordx4 v[36:39], v15, s[12:15], s26 offen offset:0 sc1
    v_exp_f32 v4, -v104
    v_exp_f32 v5, -v105
    v_exp_f32 v6, -v106
    v_mfma_f32_32x32x16_bf16 v[64:79], a[232:235], v[40:43], v[64:79]
    v_exp_f32 v7, -v107
    v_exp_f32 v8, -v108
    v_exp_f32 v9, -v109
    v_exp_f32 v10, -v110
    v_exp_f32 v11, -v111
    v_add_f32 v4, 1.0, v4
    v_add_f32 v5, 1.0, v5
    v_add_f32 v6, 1.0, v6
    v_add_f32 v7, 1.0, v7
    v_add_f32 v8, 1.0, v8
    v_add_f32 v9, 1.0, v9
    v_add_f32 v10, 1.0, v10
    v_add_f32 v11, 1.0, v11
    v_rcp_f32 v4, v4
    v_rcp_f32 v5, v5
    v_rcp_f32 v6, v6
    v_mfma_f32_32x32x16_bf16 v[80:95], a[236:239], v[40:43], v[80:95]
    v_rcp_f32 v7, v7
    v_rcp_f32 v8, v8
    v_rcp_f32 v9, v9
    v_rcp_f32 v10, v10
    s_waitcnt vmcnt(7)
    v_mov_b32 v16, s29
    v_mov_b32 v17, s33
    s_mov_b64 exec, 1
    global_store_dword v16, v17, s[8:9] offset:0 sc1
    s_mov_b64 exec, -1
    v_rcp_f32 v11, v11
    v_mul_f32 v4, v104, v4
    v_mul_f32 v5, v105, v5
    v_mul_f32 v6, v106, v6
    v_mul_f32 v7, v107, v7
    v_mul_f32 v8, v108, v8
    v_mul_f32 v9, v109, v9
    v_mul_f32 v10, v110, v10
    v_mul_f32 v11, v111, v11
    v_cvt_pk_bf16_f32 v44, v4, v5
    v_cvt_pk_bf16_f32 v45, v6, v7
    v_cvt_pk_bf16_f32 v46, v8, v9
    v_mfma_f32_32x32x16_bf16 v[64:79], a[240:243], v[48:51], v[64:79]
    v_cvt_pk_bf16_f32 v47, v10, v11
    buffer_store_dwordx4 v[44:47], v15, s[12:15], s26 offen offset:2048 sc1
    v_exp_f32 v4, -v112
    v_exp_f32 v5, -v113
    v_exp_f32 v6, -v114
    v_exp_f32 v7, -v115
    v_exp_f32 v8, -v116
    v_exp_f32 v9, -v117
    v_exp_f32 v10, -v118
    v_exp_f32 v11, -v119
    v_add_f32 v4, 1.0, v4
    v_add_f32 v5, 1.0, v5
    v_add_f32 v6, 1.0, v6
    v_add_f32 v7, 1.0, v7
    v_add_f32 v8, 1.0, v8
    v_add_f32 v9, 1.0, v9
    v_mfma_f32_32x32x16_bf16 v[80:95], a[244:247], v[48:51], v[80:95]
    v_add_f32 v10, 1.0, v10
    v_add_f32 v11, 1.0, v11
    v_rcp_f32 v4, v4
    v_rcp_f32 v5, v5
    v_rcp_f32 v6, v6
    v_rcp_f32 v7, v7
    v_rcp_f32 v8, v8
    v_rcp_f32 v9, v9
    v_rcp_f32 v10, v10
    v_rcp_f32 v11, v11
    v_mul_f32 v4, v112, v4
    v_mul_f32 v5, v113, v5
    v_mul_f32 v6, v114, v6
    v_mul_f32 v7, v115, v7
    v_mul_f32 v8, v116, v8
    v_mul_f32 v9, v117, v9
    v_mfma_f32_32x32x16_bf16 v[64:79], a[248:251], v[56:59], v[64:79]
    v_mul_f32 v10, v118, v10
    v_mul_f32 v11, v119, v11
    v_cvt_pk_bf16_f32 v52, v4, v5
    v_cvt_pk_bf16_f32 v53, v6, v7
    v_cvt_pk_bf16_f32 v54, v8, v9
    v_cvt_pk_bf16_f32 v55, v10, v11
    buffer_store_dwordx4 v[52:55], v15, s[12:15], s27 offen offset:0 sc1
    v_exp_f32 v4, -v120
    v_exp_f32 v5, -v121
    v_exp_f32 v6, -v122
    v_exp_f32 v7, -v123
    v_exp_f32 v8, -v124
    v_exp_f32 v9, -v125
    v_exp_f32 v10, -v126
    v_exp_f32 v11, -v127
    v_add_f32 v4, 1.0, v4
    v_mfma_f32_32x32x16_bf16 v[80:95], a[252:255], v[56:59], v[80:95]
    v_add_f32 v5, 1.0, v5
    v_add_f32 v6, 1.0, v6
    v_add_f32 v7, 1.0, v7
    v_add_f32 v8, 1.0, v8
    v_add_f32 v9, 1.0, v9
    v_add_f32 v10, 1.0, v10
    v_add_f32 v11, 1.0, v11
    v_rcp_f32 v4, v4
    v_rcp_f32 v5, v5
    v_rcp_f32 v6, v6
    v_rcp_f32 v7, v7
    v_rcp_f32 v8, v8
    v_rcp_f32 v9, v9
    v_rcp_f32 v10, v10
    v_rcp_f32 v11, v11
    v_mul_f32 v4, v120, v4
    v_mul_f32 v5, v121, v5
    v_mul_f32 v6, v122, v6
    v_mul_f32 v7, v123, v7
    v_mul_f32 v8, v124, v8
    v_mul_f32 v9, v125, v9
    v_mul_f32 v10, v126, v10
    v_mul_f32 v11, v127, v11
    v_cvt_pk_bf16_f32 v60, v4, v5
    v_cvt_pk_bf16_f32 v61, v6, v7
    v_cvt_pk_bf16_f32 v62, v8, v9
    v_cvt_pk_bf16_f32 v63, v10, v11
    s_mov_b64 exec, 0x7f
    global_load_dword v22, v24, s[8:9] offset:0 sc1
    s_mov_b64 exec, -1
    buffer_store_dwordx4 v[60:63], v15, s[12:15], s27 offen offset:2048 sc1
    v_mfma_f32_32x32x16_bf16 v[96:111], a[224:227], v[36:39], 0
    v_mfma_f32_32x32x16_bf16 v[112:127], a[228:231], v[36:39], 0
    v_mfma_f32_32x32x16_bf16 v[96:111], a[232:235], v[44:47], v[96:111]
    v_mfma_f32_32x32x16_bf16 v[112:127], a[236:239], v[44:47], v[112:127]
    v_mfma_f32_32x32x16_bf16 v[96:111], a[240:243], v[52:55], v[96:111]
    v_mfma_f32_32x32x16_bf16 v[112:127], a[244:247], v[52:55], v[112:127]
    v_mfma_f32_32x32x16_bf16 v[96:111], a[248:251], v[60:63], v[96:111]
    v_mfma_f32_32x32x16_bf16 v[112:127], a[252:255], v[60:63], v[112:127]
    s_barrier
    s_waitcnt vmcnt(0)
    v_mov_b32 v16, s29
    v_mov_b32 v17, s33
    s_mov_b64 exec, 1
    global_store_dword v16, v17, s[8:9] offset:32 sc1
    s_mov_b64 exec, -1
    s_mov_b32 s30, 0
    s_mov_b64 exec, 0x7f
M_poll0:
    v_cmp_ne_u32 vcc, s33, v22
    s_add_u32 s30, s30, 1
    s_nop 3
    s_cbranch_vccz M_poll_done0
    global_load_dword v22, v24, s[8:9] offset:0 sc1
    s_cmp_lt_u32 s30, 0x100000
    s_waitcnt vmcnt(0)
    s_cbranch_scc1 M_poll0
M_poll_done0:
    s_mov_b64 exec, -1
    buffer_load_dwordx4 a[64:67], v14, s[12:15], s51 offen offset:0
    buffer_load_dwordx4 a[72:75], v14, s[12:15], s51 offen offset:2048
    buffer_load_dwordx4 a[80:83], v14, s[12:15], s61 offen offset:0
    buffer_load_dwordx4 a[88:91], v14, s[12:15], s61 offen offset:2048
    buffer_load_dwordx4 a[96:99], v14, s[12:15], s52 offen offset:0
    buffer_load_dwordx4 a[104:107], v14, s[12:15], s52 offen offset:2048
    buffer_load_dwordx4 a[112:115], v14, s[12:15], s62 offen offset:0
    buffer_load_dwordx4 a[120:123], v14, s[12:15], s62 offen offset:2048
    s_waitcnt vmcnt(7)
    v_mfma_f32_32x32x16_bf16 v[64:79], v[128:131], a[64:67], v[64:79]
    v_bfe_u32 v8, v0, 5, 1
    v_lshlrev_b32 v8, 4, v8
    s_lshl_b32 s31, s5, 8
    v_mfma_f32_32x32x16_bf16 v[80:95], v[132:135], a[64:67], v[80:95]
    s_lshr_b32 s32, s20, 3
    s_add_u32 s31, s31, s32
    s_add_u32 s31, s31, 2171648
    buffer_load_dwordx4 a[128:131], v14, s[12:15], s53 offen offset:0
    s_waitcnt vmcnt(7)
    v_mfma_f32_32x32x16_bf16 v[64:79], v[136:139], a[72:75], v[64:79]
    v_add_u32 v8, s31, v8
    s_lshl_b32 s31, s5, 1
    s_lshr_b32 s32, s6, 1
    v_mfma_f32_32x32x16_bf16 v[80:95], v[140:143], a[72:75], v[80:95]
    s_add_u32 s31, s31, s32
    s_and_b32 s31, s31, 3
    s_add_u32 s31, s31, 252
    buffer_load_dwordx4 a[136:139], v14, s[12:15], s53 offen offset:2048
    s_waitcnt vmcnt(7)
    v_mfma_f32_32x32x16_bf16 v[64:79], v[144:147], a[80:83], v[64:79]
    s_lshl_b32 s31, s31, 6
    s_add_u32 s31, s31, 2326528
    v_mov_b32 v26, s31
    v_mfma_f32_32x32x16_bf16 v[80:95], v[148:151], a[80:83], v[80:95]
    s_xor_b32 s34, s6, 1
    s_mul_i32 s34, s34, 12288
    s_add_u32 s34, s34, 0
    buffer_load_dwordx4 a[144:147], v14, s[12:15], s63 offen offset:0
    s_waitcnt vmcnt(7)
    v_mfma_f32_32x32x16_bf16 v[64:79], v[152:155], a[88:91], v[64:79]
    v_add_u32 v9, s34, v1
    s_xor_b32 s34, s6, 2
    s_mul_i32 s34, s34, 12288
    v_mfma_f32_32x32x16_bf16 v[80:95], v[156:159], a[88:91], v[80:95]
    s_add_u32 s34, s34, 4096
    v_add_u32 v10, s34, v1
    s_xor_b32 s34, s6, 3
    buffer_load_dwordx4 a[152:155], v14, s[12:15], s63 offen offset:2048
    s_waitcnt vmcnt(7)
    v_mfma_f32_32x32x16_bf16 v[64:79], v[160:163], a[96:99], v[64:79]
    s_mul_i32 s34, s34, 12288
    s_add_u32 s34, s34, 8192
    v_add_u32 v11, s34, v1
    v_mfma_f32_32x32x16_bf16 v[80:95], v[164:167], a[96:99], v[80:95]
    s_mul_i32 s34, s6, 12288
    v_add_u32 v12, s34, v1
    v_bfe_u32 v13, v0, 5, 1
    buffer_load_dwordx4 a[160:163], v14, s[12:15], s54 offen offset:0
    s_waitcnt vmcnt(7)
    v_mfma_f32_32x32x16_bf16 v[64:79], v[168:171], a[104:107], v[64:79]
    v_lshlrev_b32 v4, 9, v13
    v_sub_u32 v4, v2, v4
    s_lshl_b32 s34, s20, 2
    v_mfma_f32_32x32x16_bf16 v[80:95], v[172:175], a[104:107], v[80:95]
    s_add_u32 s34, s34, 57344
    v_add_u32 v4, s34, v4
    v_and_b32 v5, 31, v0
    buffer_load_dwordx4 a[168:171], v14, s[12:15], s54 offen offset:2048
    s_waitcnt vmcnt(7)
    v_mfma_f32_32x32x16_bf16 v[64:79], v[176:179], a[112:115], v[64:79]
    v_mul_u32_u24 v5, 896, v5
    v_lshl_add_u32 v5, v13, 4, v5
    s_lshl_b32 s34, s4, 1
    v_mfma_f32_32x32x16_bf16 v[80:95], v[180:183], a[112:115], v[80:95]
    s_and_b32 s35, s6, 1
    s_add_u32 s34, s34, s35
    s_mul_i32 s34, s34, 28672
    s_mov_b64 exec, 0x7f
    global_load_dword v23, v24, s[8:9] offset:32 sc1
    s_mov_b64 exec, -1
    buffer_load_dwordx4 a[176:179], v14, s[12:15], s64 offen offset:0
    s_waitcnt vmcnt(8)
    v_mfma_f32_32x32x16_bf16 v[64:79], v[184:187], a[120:123], v[64:79]
    s_lshl_b32 s35, s5, 7
    s_add_u32 s34, s34, s35
    s_lshr_b32 s35, s20, 4
    v_mfma_f32_32x32x16_bf16 v[80:95], v[188:191], a[120:123], v[80:95]
    s_add_u32 s34, s34, s35
    v_add_u32 v5, s34, v5
    s_mov_b32 s36, 1060205080
    buffer_load_dwordx4 a[184:187], v14, s[12:15], s64 offen offset:2048
    s_waitcnt vmcnt(8)
    v_mfma_f32_32x32x16_bf16 v[64:79], v[192:195], a[128:131], v[64:79]
    s_mov_b32 s37, s36
    v_mfma_f32_32x32x16_bf16 v[80:95], v[196:199], a[128:131], v[80:95]
    buffer_load_dwordx4 a[192:195], v14, s[12:15], s55 offen offset:0
    s_waitcnt vmcnt(8)
    v_mfma_f32_32x32x16_bf16 v[64:79], v[200:203], a[136:139], v[64:79]
    v_mfma_f32_32x32x16_bf16 v[80:95], v[204:207], a[136:139], v[80:95]
    buffer_load_dwordx4 a[200:203], v14, s[12:15], s55 offen offset:2048
    s_waitcnt vmcnt(8)
    v_mfma_f32_32x32x16_bf16 v[64:79], v[208:211], a[144:147], v[64:79]
    v_mfma_f32_32x32x16_bf16 v[80:95], v[212:215], a[144:147], v[80:95]
    global_load_dword v27, v26, s[8:9] sc1
    buffer_load_dwordx4 a[208:211], v14, s[12:15], s65 offen offset:0
    s_waitcnt vmcnt(9)
    v_mfma_f32_32x32x16_bf16 v[64:79], v[216:219], a[152:155], v[64:79]
    v_mfma_f32_32x32x16_bf16 v[80:95], v[220:223], a[152:155], v[80:95]
    buffer_load_dwordx4 a[216:219], v14, s[12:15], s65 offen offset:2048
    s_waitcnt vmcnt(9)
    v_mfma_f32_32x32x16_bf16 v[64:79], v[224:227], a[160:163], v[64:79]
    v_mfma_f32_32x32x16_bf16 v[80:95], v[228:231], a[160:163], v[80:95]
    buffer_load_dwordx4 v[32:35], v14, s[12:15], s56 offen offset:0
    s_waitcnt vmcnt(9)
    v_mfma_f32_32x32x16_bf16 v[64:79], v[232:235], a[168:171], v[64:79]
    v_mfma_f32_32x32x16_bf16 v[80:95], v[236:239], a[168:171], v[80:95]
    buffer_load_dwordx4 v[40:43], v14, s[12:15], s56 offen offset:2048
    s_waitcnt vmcnt(8)
    v_mfma_f32_32x32x16_bf16 v[64:79], v[240:243], a[176:179], v[64:79]
    v_mfma_f32_32x32x16_bf16 v[80:95], v[244:247], a[176:179], v[80:95]
    buffer_load_dwordx4 v[48:51], v14, s[12:15], s66 offen offset:0
    s_waitcnt vmcnt(8)
    v_mfma_f32_32x32x16_bf16 v[64:79], v[248:251], a[184:187], v[64:79]
    v_mfma_f32_32x32x16_bf16 v[80:95], v[252:255], a[184:187], v[80:95]
    buffer_load_dwordx4 v[56:59], v14, s[12:15], s66 offen offset:2048
    s_waitcnt vmcnt(8)
    v_mfma_f32_32x32x16_bf16 v[64:79], a[0:3], a[192:195], v[64:79]
    v_mfma_f32_32x32x16_bf16 v[80:95], a[4:7], a[192:195], v[80:95]
    s_mov_b32 s30, 0
    s_mov_b64 exec, 0x7f
M_poll1:
    v_cmp_ne_u32 vcc, s33, v23
    s_add_u32 s30, s30, 1
    s_nop 3
    s_cbranch_vccz M_poll_done1
    global_load_dword v23, v24, s[8:9] offset:32 sc1
    s_cmp_lt_u32 s30, 0x100000
    s_waitcnt vmcnt(0)
    s_cbranch_scc1 M_poll1
M_poll_done1:
    s_mov_b64 exec, -1
    buffer_load_dwordx4 a[68:71], v15, s[12:15], s51 offen offset:0
    s_waitcnt vmcnt(8)
    v_mfma_f32_32x32x16_bf16 v[64:79], a[8:11], a[200:203], v[64:79]
    v_mfma_f32_32x32x16_bf16 v[80:95], a[12:15], a[200:203], v[80:95]
    buffer_load_dwordx4 a[76:79], v15, s[12:15], s51 offen offset:2048
    s_waitcnt vmcnt(7)
    v_mfma_f32_32x32x16_bf16 v[64:79], a[16:19], a[208:211], v[64:79]
    v_mfma_f32_32x32x16_bf16 v[80:95], a[20:23], a[208:211], v[80:95]
    buffer_load_dwordx4 a[84:87], v15, s[12:15], s61 offen offset:0
    s_waitcnt vmcnt(7)
    v_mfma_f32_32x32x16_bf16 v[64:79], a[24:27], a[216:219], v[64:79]
    v_mfma_f32_32x32x16_bf16 v[80:95], a[28:31], a[216:219], v[80:95]
    buffer_load_dwordx4 a[92:95], v15, s[12:15], s61 offen offset:2048
    s_waitcnt vmcnt(7)
    v_mfma_f32_32x32x16_bf16 v[64:79], a[32:35], v[32:35], v[64:79]
    v_mfma_f32_32x32x16_bf16 v[80:95], a[36:39], v[32:35], v[80:95]
    buffer_load_dwordx4 a[100:103], v15, s[12:15], s52 offen offset:0
    s_mov_b32 s35, 0
M_pollE:
    v_cmp_ne_u32 vcc, s33, v27
    s_add_u32 s35, s35, 1
    s_nop 3
    s_cbranch_vccz M_pollE_done
    s_sleep 2
    global_load_dword v27, v26, s[8:9] sc1
    s_cmp_lt_u32 s35, 0x100000
    s_waitcnt vmcnt(0)
    s_cbranch_scc1 M_pollE
M_pollE_done:
    global_load_dwordx4 v[16:19], v8, s[8:9] offset:0
    global_load_dwordx4 v[20:23], v8, s[8:9] offset:32
    global_load_dwordx4 v[24:27], v8, s[8:9] offset:64
    global_load_dwordx4 v[28:31], v8, s[8:9] offset:96
    s_waitcnt vmcnt(11)
    v_mfma_f32_32x32x16_bf16 v[64:79], a[40:43], v[40:43], v[64:79]
    v_mfma_f32_32x32x16_bf16 v[80:95], a[44:47], v[40:43], v[80:95]
    buffer_load_dwordx4 a[108:111], v15, s[12:15], s52 offen offset:2048
    s_waitcnt vmcnt(11)
    v_mfma_f32_32x32x16_bf16 v[64:79], a[48:51], v[48:51], v[64:79]
    v_mfma_f32_32x32x16_bf16 v[80:95], a[52:55], v[48:51], v[80:95]
    buffer_load_dwordx4 a[116:119], v15, s[12:15], s62 offen offset:0
    s_waitcnt vmcnt(11)
    v_mfma_f32_32x32x16_bf16 v[64:79], a[56:59], v[56:59], v[64:79]
    v_mfma_f32_32x32x16_bf16 v[80:95], a[60:63], v[56:59], v[80:95]
    buffer_load_dwordx4 a[124:127], v15, s[12:15], s62 offen offset:2048
    s_waitcnt vmcnt(11)
    v_mfma_f32_32x32x16_bf16 v[96:111], v[128:131], a[68:71], v[96:111]
    v_mfma_f32_32x32x16_bf16 v[112:127], v[132:135], a[68:71], v[112:127]
    buffer_load_dwordx4 a[132:135], v15, s[12:15], s53 offen offset:0
    s_waitcnt vmcnt(11)
    v_mfma_f32_32x32x16_bf16 v[96:111], v[136:139], a[76:79], v[96:111]
    v_mfma_f32_32x32x16_bf16 v[112:127], v[140:143], a[76:79], v[112:127]
    buffer_load_dwordx4 a[140:143], v15, s[12:15], s53 offen offset:2048
    s_waitcnt vmcnt(11)
    v_mfma_f32_32x32x16_bf16 v[96:111], v[144:147], a[84:87], v[96:111]
    v_mfma_f32_32x32x16_bf16 v[112:127], v[148:151], a[84:87], v[112:127]
    buffer_load_dwordx4 a[148:151], v15, s[12:15], s63 offen offset:0
    s_waitcnt vmcnt(11)
    v_mfma_f32_32x32x16_bf16 v[96:111], v[152:155], a[92:95], v[96:111]
    v_mfma_f32_32x32x16_bf16 v[112:127], v[156:159], a[92:95], v[112:127]
    buffer_load_dwordx4 a[156:159], v15, s[12:15], s63 offen offset:2048
    s_waitcnt vmcnt(11)
    v_mfma_f32_32x32x16_bf16 v[96:111], v[160:163], a[100:103], v[96:111]
    v_mfma_f32_32x32x16_bf16 v[112:127], v[164:167], a[100:103], v[112:127]
    buffer_load_dwordx4 a[164:167], v15, s[12:15], s54 offen offset:0
    s_waitcnt vmcnt(7)
    v_mfma_f32_32x32x16_bf16 v[96:111], v[168:171], a[108:111], v[96:111]
    ds_write_b128 v10, v[80:83] offset:0
    v_mfma_f32_32x32x16_bf16 v[112:127], v[172:175], a[108:111], v[112:127]
    buffer_load_dwordx4 a[172:175], v15, s[12:15], s54 offen offset:2048
    s_waitcnt vmcnt(7)
    v_mfma_f32_32x32x16_bf16 v[96:111], v[176:179], a[116:119], v[96:111]
    ds_write_b128 v10, v[84:87] offset:1024
    v_mfma_f32_32x32x16_bf16 v[112:127], v[180:183], a[116:119], v[112:127]
    buffer_load_dwordx4 a[180:183], v15, s[12:15], s64 offen offset:0
    s_waitcnt vmcnt(7)
    v_mfma_f32_32x32x16_bf16 v[96:111], v[184:187], a[124:127], v[96:111]
    ds_write_b128 v10, v[88:91] offset:2048
    v_mfma_f32_32x32x16_bf16 v[112:127], v[188:191], a[124:127], v[112:127]
    buffer_load_dwordx4 a[188:191], v15, s[12:15], s64 offen offset:2048
    s_waitcnt vmcnt(7)
    v_mfma_f32_32x32x16_bf16 v[96:111], v[192:195], a[132:135], v[96:111]
    ds_write_b128 v10, v[92:95] offset:3072
    v_mfma_f32_32x32x16_bf16 v[112:127], v[196:199], a[132:135], v[112:127]
    buffer_load_dwordx4 a[196:199], v15, s[12:15], s55 offen offset:0
    s_waitcnt vmcnt(7)
    v_mfma_f32_32x32x16_bf16 v[96:111], v[200:203], a[140:143], v[96:111]
    ds_read_b64_tr_b16 v[128:129], v4 offset:0
    v_mfma_f32_32x32x16_bf16 v[112:127], v[204:207], a[140:143], v[112:127]
    buffer_load_dwordx4 a[204:207], v15, s[12:15], s55 offen offset:2048
    s_waitcnt vmcnt(7)
    v_mfma_f32_32x32x16_bf16 v[96:111], v[208:211], a[148:151], v[96:111]
    ds_read_b64_tr_b16 v[130:131], v4 offset:1024
    v_mfma_f32_32x32x16_bf16 v[112:127], v[212:215], a[148:151], v[112:127]
    buffer_load_dwordx4 a[212:215], v15, s[12:15], s65 offen offset:0
    s_waitcnt vmcnt(7)
    v_mfma_f32_32x32x16_bf16 v[96:111], v[216:219], a[156:159], v[96:111]
    ds_read_b64_tr_b16 v[132:133], v4 offset:2048
    v_mfma_f32_32x32x16_bf16 v[112:127], v[220:223], a[156:159], v[112:127]
    buffer_load_dwordx4 a[220:223], v15, s[12:15], s65 offen offset:2048
    s_waitcnt vmcnt(7)
    v_mfma_f32_32x32x16_bf16 v[96:111], v[224:227], a[164:167], v[96:111]
    ds_read_b64_tr_b16 v[134:135], v4 offset:3072
    v_mfma_f32_32x32x16_bf16 v[112:127], v[228:231], a[164:167], v[112:127]
    buffer_load_dwordx4 v[36:39], v15, s[12:15], s56 offen offset:0
    s_waitcnt vmcnt(7)
    v_mfma_f32_32x32x16_bf16 v[96:111], v[232:235], a[172:175], v[96:111]
    v_mfma_f32_32x32x16_bf16 v[112:127], v[236:239], a[172:175], v[112:127]
    buffer_load_dwordx4 v[44:47], v15, s[12:15], s56 offen offset:2048
    s_waitcnt vmcnt(7)
    v_mfma_f32_32x32x16_bf16 v[96:111], v[240:243], a[180:183], v[96:111]
    v_mfma_f32_32x32x16_bf16 v[112:127], v[244:247], a[180:183], v[112:127]
    buffer_load_dwordx4 v[52:55], v15, s[12:15], s66 offen offset:0
    s_waitcnt lgkmcnt(0)
    s_waitcnt vmcnt(7)
    v_mfma_f32_32x32x16_bf16 v[96:111], v[248:251], a[188:191], v[96:111]
    v_pk_mul_f32 v[16:17], v[16:17], s[36:37]
    v_pk_mul_f32 v[18:19], v[18:19], s[36:37]
    v_mfma_f32_32x32x16_bf16 v[112:127], v[252:255], a[188:191], v[112:127]
    buffer_load_dwordx4 v[60:63], v15, s[12:15], s66 offen offset:2048
    s_waitcnt vmcnt(7)
    v_mfma_f32_32x32x16_bf16 v[96:111], a[0:3], a[196:199], v[96:111]
    v_pk_mul_f32 v[20:21], v[20:21], s[36:37]
    v_pk_mul_f32 v[22:23], v[22:23], s[36:37]
    v_mfma_f32_32x32x16_bf16 v[112:127], a[4:7], a[196:199], v[112:127]
    s_waitcnt vmcnt(6)
    v_mfma_f32_32x32x16_bf16 v[96:111], a[8:11], a[204:207], v[96:111]
    v_pk_mul_f32 v[24:25], v[24:25], s[36:37]
    v_pk_mul_f32 v[26:27], v[26:27], s[36:37]
    v_mfma_f32_32x32x16_bf16 v[112:127], a[12:15], a[204:207], v[112:127]
    s_waitcnt vmcnt(5)
    v_mfma_f32_32x32x16_bf16 v[96:111], a[16:19], a[212:215], v[96:111]
    v_pk_mul_f32 v[28:29], v[28:29], s[36:37]
    v_pk_mul_f32 v[30:31], v[30:31], s[36:37]
    v_mfma_f32_32x32x16_bf16 v[112:127], a[20:23], a[212:215], v[112:127]
    s_waitcnt vmcnt(4)
    v_mfma_f32_32x32x16_bf16 v[96:111], a[24:27], a[220:223], v[96:111]
    v_lshlrev_b32 v136, 16, v128
    v_and_b32 v137, 0xffff0000, v128
    v_lshlrev_b32 v138, 16, v129
    v_and_b32 v139, 0xffff0000, v129
    v_mfma_f32_32x32x16_bf16 v[112:127], a[28:31], a[220:223], v[112:127]
    s_waitcnt vmcnt(3)
    v_mfma_f32_32x32x16_bf16 v[96:111], a[32:35], v[36:39], v[96:111]
    v_lshlrev_b32 v140, 16, v130
    v_and_b32 v141, 0xffff0000, v130
    v_lshlrev_b32 v142, 16, v131
    v_and_b32 v143, 0xffff0000, v131
    v_mfma_f32_32x32x16_bf16 v[112:127], a[36:39], v[36:39], v[112:127]
    s_waitcnt vmcnt(2)
    v_mfma_f32_32x32x16_bf16 v[96:111], a[40:43], v[44:47], v[96:111]
    v_lshlrev_b32 v144, 16, v132
    v_and_b32 v145, 0xffff0000, v132
    v_lshlrev_b32 v146, 16, v133
    v_and_b32 v147, 0xffff0000, v133
    v_mfma_f32_32x32x16_bf16 v[112:127], a[44:47], v[44:47], v[112:127]
    s_waitcnt vmcnt(1)
    v_mfma_f32_32x32x16_bf16 v[96:111], a[48:51], v[52:55], v[96:111]
    v_lshlrev_b32 v148, 16, v134
    v_and_b32 v149, 0xffff0000, v134
    v_lshlrev_b32 v150, 16, v135
    v_and_b32 v151, 0xffff0000, v135
    v_mfma_f32_32x32x16_bf16 v[112:127], a[52:55], v[52:55], v[112:127]
    s_waitcnt vmcnt(0)
    v_mfma_f32_32x32x16_bf16 v[96:111], a[56:59], v[60:63], v[96:111]
    v_mfma_f32_32x32x16_bf16 v[112:127], a[60:63], v[60:63], v[112:127]
    s_nop 10
    ds_write_b128 v9, v[96:99] offset:0
    ds_write_b128 v9, v[100:103] offset:1024
    ds_write_b128 v9, v[104:107] offset:2048
    ds_write_b128 v9, v[108:111] offset:3072
    ds_write_b128 v11, v[112:115] offset:0
    ds_write_b128 v11, v[116:119] offset:1024
    ds_write_b128 v11, v[120:123] offset:2048
    ds_write_b128 v11, v[124:127] offset:3072
    s_waitcnt lgkmcnt(0)
    s_barrier
    ds_read_b128 v[80:83], v12 offset:0
    ds_read_b128 v[84:87], v12 offset:1024
    ds_read_b128 v[88:91], v12 offset:2048
    ds_read_b128 v[92:95], v12 offset:3072
    ds_read_b128 v[96:99], v12 offset:4096
    ds_read_b128 v[100:103], v12 offset:5120
    ds_read_b128 v[104:107], v12 offset:6144
    ds_read_b128 v[108:111], v12 offset:7168
    ds_read_b128 v[112:115], v12 offset:8192
    ds_read_b128 v[116:119], v12 offset:9216
    ds_read_b128 v[120:123], v12 offset:10240
    ds_read_b128 v[124:127], v12 offset:11264
    s_waitcnt lgkmcnt(11)
    v_pk_add_f32 v[64:65], v[64:65], v[80:81]
    v_pk_add_f32 v[66:67], v[66:67], v[82:83]
    s_waitcnt lgkmcnt(10)
    v_pk_add_f32 v[68:69], v[68:69], v[84:85]
    v_pk_add_f32 v[70:71], v[70:71], v[86:87]
    s_waitcnt lgkmcnt(9)
    v_pk_add_f32 v[72:73], v[72:73], v[88:89]
    v_pk_add_f32 v[74:75], v[74:75], v[90:91]
    s_waitcnt lgkmcnt(8)
    v_pk_add_f32 v[76:77], v[76:77], v[92:93]
    v_pk_add_f32 v[78:79], v[78:79], v[94:95]
    s_waitcnt lgkmcnt(7)
    v_pk_add_f32 v[64:65], v[64:65], v[96:97]
    v_pk_add_f32 v[66:67], v[66:67], v[98:99]
    s_waitcnt lgkmcnt(6)
    v_pk_add_f32 v[68:69], v[68:69], v[100:101]
    v_pk_add_f32 v[70:71], v[70:71], v[102:103]
    s_waitcnt lgkmcnt(5)
    v_pk_add_f32 v[72:73], v[72:73], v[104:105]
    v_pk_add_f32 v[74:75], v[74:75], v[106:107]
    s_waitcnt lgkmcnt(4)
    v_pk_add_f32 v[76:77], v[76:77], v[108:109]
    v_pk_add_f32 v[78:79], v[78:79], v[110:111]
    s_waitcnt lgkmcnt(3)
    v_pk_add_f32 v[64:65], v[64:65], v[112:113]
    v_pk_add_f32 v[66:67], v[66:67], v[114:115]
    s_waitcnt lgkmcnt(2)
    v_pk_add_f32 v[68:69], v[68:69], v[116:117]
    v_pk_add_f32 v[70:71], v[70:71], v[118:119]
    s_waitcnt lgkmcnt(1)
    v_pk_add_f32 v[72:73], v[72:73], v[120:121]
    v_pk_add_f32 v[74:75], v[74:75], v[122:123]
    s_waitcnt lgkmcnt(0)
    v_pk_add_f32 v[76:77], v[76:77], v[124:125]
    v_pk_add_f32 v[78:79], v[78:79], v[126:127]
    v_pk_fma_f32 v[136:137], v[64:65], v[16:17], v[136:137]
    v_pk_fma_f32 v[138:139], v[66:67], v[18:19], v[138:139]
    v_pk_fma_f32 v[140:141], v[68:69], v[20:21], v[140:141]
    v_pk_fma_f32 v[142:143], v[70:71], v[22:23], v[142:143]
    v_pk_fma_f32 v[144:145], v[72:73], v[24:25], v[144:145]
    v_pk_fma_f32 v[146:147], v[74:75], v[26:27], v[146:147]
    v_pk_fma_f32 v[148:149], v[76:77], v[28:29], v[148:149]
    v_pk_fma_f32 v[150:151], v[78:79], v[30:31], v[150:151]
    v_cvt_pk_bf16_f32 v32, v136, v137
    v_cvt_pk_bf16_f32 v33, v138, v139
    v_cvt_pk_bf16_f32 v34, v140, v141
    v_cvt_pk_bf16_f32 v35, v142, v143
    v_cvt_pk_bf16_f32 v36, v144, v145
    v_cvt_pk_bf16_f32 v37, v146, v147
    v_cvt_pk_bf16_f32 v38, v148, v149
    v_cvt_pk_bf16_f32 v39, v150, v151
    v_permlane32_swap_b32 v32, v34
    v_permlane32_swap_b32 v33, v35
    v_permlane32_swap_b32 v36, v38
    v_permlane32_swap_b32 v37, v39
    global_store_dwordx4 v5, v[32:35], s[10:11] offset:0
    global_store_dwordx4 v5, v[36:39], s[10:11] offset:32
F_end:
    s_endpgm
F_spare:
    s_load_dwordx4 s[24:27], s[0:1], 80
    s_sub_u32 s34, s2, 224
    v_and_b32 v5, 3, v0
    v_lshrrev_b32 v153, 2, v0
    v_mul_u32_u24 v154, 5376, v153
    v_lshl_add_u32 v154, v5, 4, v154
    v_lshlrev_b32 v152, 1, v153
    v_mov_b32 v153, 0
    s_mov_b32 s74, 2408448
    s_mov_b32 s75, 0x20000
    s_memrealtime s[36:37]
    s_waitcnt lgkmcnt(0)
    s_mov_b32 s8, s78
    s_mov_b32 s9, s79
    s_mov_b32 s72, s66
    s_mov_b32 s73, s67
    v_mov_b32 v151, 0
    s_or_b32 s3, s34, s6
    s_cmp_lg_u32 s3, 0
    s_cbranch_scc1 F_sp_nn
    s_or_b32 s36, s36, 1
    v_mov_b32 v9, s36
    s_mov_b64 exec, 1
    global_store_dword v153, v9, s[76:77] sc1
    s_mov_b64 exec, -1
F_sp_nn:
    s_cmp_ge_u32 s34, 28
    s_cbranch_scc1 F_sp_modonly
    v_and_b32 v3, 63, v0
    v_lshlrev_b32 v1, 4, v3
    v_lshrrev_b32 v6, 3, v3
    v_and_b32 v7, 7, v0
    s_lshl_b32 s7, s6, 4
    v_add_u32 v6, s7, v6
    v_lshlrev_b32 v7, 4, v7
    s_movk_i32 s16, 3584
    v_mad_u32_u24 v8, v6, s16, v7
    s_lshl_b32 s17, s34, 7
    v_add_u32 v8, s17, v8
    v_add_u32 v9, 28672, v8
    global_load_dwordx4 v[160:163], v8, s[24:25]
    global_load_dwordx4 v[164:167], v9, s[24:25]
    v_add_u32 v8, 229376, v8
    v_add_u32 v9, 229376, v9
    global_load_dwordx4 v[168:171], v8, s[24:25]
    global_load_dwordx4 v[172:175], v9, s[24:25]
    v_add_u32 v8, 229376, v8
    v_add_u32 v9, 229376, v9
    global_load_dwordx4 v[176:179], v8, s[24:25]
    global_load_dwordx4 v[180:183], v9, s[24:25]
    v_add_u32 v8, 229376, v8
    v_add_u32 v9, 229376, v9
    global_load_dwordx4 v[184:187], v8, s[24:25]
    global_load_dwordx4 v[188:191], v9, s[24:25]
    v_add_u32 v8, 229376, v8
    v_add_u32 v9, 229376, v9
    global_load_dwordx4 v[192:195], v8, s[24:25]
    global_load_dwordx4 v[196:199], v9, s[24:25]
    v_add_u32 v8, 229376, v8
    v_add_u32 v9, 229376, v9
    global_load_dwordx4 v[200:203], v8, s[24:25]
    global_load_dwordx4 v[204:207], v9, s[24:25]
    v_add_u32 v8, 229376, v8
    v_add_u32 v9, 229376, v9
    global_load_dwordx4 v[208:211], v8, s[24:25]
    global_load_dwordx4 v[212:215], v9, s[24:25]
    s_mul_i32 s7, s6, 14336
    v_bfe_u32 v10, v0, 4, 1
    v_lshlrev_b32 v11, 6, v10
    v_xor_b32 v12, v1, v11
    v_add_u32 v12, s7, v12
    v_bfe_u32 v6, v0, 5, 1
    v_bfe_u32 v13, v0, 2, 2
    v_lshlrev_b32 v13, 7, v13
    v_lshl_add_u32 v13, v10, 5, v13
    v_and_b32 v10, 3, v0
    v_lshl_add_u32 v13, v10, 3, v13
    v_bfe_u32 v10, v0, 3, 1
    v_lshlrev_b32 v10, 6, v10
    v_xor_b32 v13, v13, v10
    v_add_u32 v13, s7, v13
    v_lshl_add_u32 v13, v6, 10, v13
    v_xor_b32 v14, 64, v13
    s_mul_i32 s17, s34, 57344
    s_add_u32 s17, s17, 3145728
    s_lshl_b32 s7, s6, 11
    s_add_u32 s17, s17, s7
    v_add_u32 v15, s17, v1
    s_waitcnt vmcnt(12)
    ds_write_b128 v12, v[160:163] offset:0
    ds_write_b128 v12, v[164:167] offset:1024
    s_waitcnt lgkmcnt(0)
    ds_read_b64_tr_b16 v[160:161], v13 offset:0
    ds_read_b64_tr_b16 v[162:163], v13 offset:512
    ds_read_b64_tr_b16 v[164:165], v14 offset:0
    ds_read_b64_tr_b16 v[166:167], v14 offset:512
    s_waitcnt vmcnt(10)
    ds_write_b128 v12, v[168:171] offset:2048
    ds_write_b128 v12, v[172:175] offset:3072
    s_waitcnt lgkmcnt(2)
    global_store_dwordx4 v15, v[160:163], s[8:9] sc1
    global_store_dwordx4 v15, v[164:167], s[8:9] offset:1024 sc1
    v_add_u32 v15, 8192, v15
    s_waitcnt lgkmcnt(0)
    ds_read_b64_tr_b16 v[168:169], v13 offset:2048
    ds_read_b64_tr_b16 v[170:171], v13 offset:2560
    ds_read_b64_tr_b16 v[172:173], v14 offset:2048
    ds_read_b64_tr_b16 v[174:175], v14 offset:2560
    s_waitcnt vmcnt(10)
    ds_write_b128 v12, v[176:179] offset:4096
    ds_write_b128 v12, v[180:183] offset:5120
    s_waitcnt lgkmcnt(2)
    global_store_dwordx4 v15, v[168:171], s[8:9] sc1
    global_store_dwordx4 v15, v[172:175], s[8:9] offset:1024 sc1
    v_add_u32 v15, 8192, v15
    s_waitcnt lgkmcnt(0)
    ds_read_b64_tr_b16 v[176:177], v13 offset:4096
    ds_read_b64_tr_b16 v[178:179], v13 offset:4608
    ds_read_b64_tr_b16 v[180:181], v14 offset:4096
    ds_read_b64_tr_b16 v[182:183], v14 offset:4608
    s_waitcnt vmcnt(10)
    ds_write_b128 v12, v[184:187] offset:6144
    ds_write_b128 v12, v[188:191] offset:7168
    s_waitcnt lgkmcnt(2)
    global_store_dwordx4 v15, v[176:179], s[8:9] sc1
    global_store_dwordx4 v15, v[180:183], s[8:9] offset:1024 sc1
    v_add_u32 v15, 8192, v15
    s_waitcnt lgkmcnt(0)
    ds_read_b64_tr_b16 v[184:185], v13 offset:6144
    ds_read_b64_tr_b16 v[186:187], v13 offset:6656
    ds_read_b64_tr_b16 v[188:189], v14 offset:6144
    ds_read_b64_tr_b16 v[190:191], v14 offset:6656
    s_waitcnt vmcnt(10)
    ds_write_b128 v12, v[192:195] offset:8192
    ds_write_b128 v12, v[196:199] offset:9216
    s_waitcnt lgkmcnt(2)
    global_store_dwordx4 v15, v[184:187], s[8:9] sc1
    global_store_dwordx4 v15, v[188:191], s[8:9] offset:1024 sc1
    v_add_u32 v15, 8192, v15
    s_waitcnt lgkmcnt(0)
    ds_read_b64_tr_b16 v[192:193], v13 offset:8192
    ds_read_b64_tr_b16 v[194:195], v13 offset:8704
    ds_read_b64_tr_b16 v[196:197], v14 offset:8192
    ds_read_b64_tr_b16 v[198:199], v14 offset:8704
    s_waitcnt vmcnt(10)
    ds_write_b128 v12, v[200:203] offset:10240
    ds_write_b128 v12, v[204:207] offset:11264
    s_waitcnt lgkmcnt(2)
    global_store_dwordx4 v15, v[192:195], s[8:9] sc1
    global_store_dwordx4 v15, v[196:199], s[8:9] offset:1024 sc1
    v_add_u32 v15, 8192, v15
    s_waitcnt lgkmcnt(0)
    ds_read_b64_tr_b16 v[200:201], v13 offset:10240
    ds_read_b64_tr_b16 v[202:203], v13 offset:10752
    ds_read_b64_tr_b16 v[204:205], v14 offset:10240
    ds_read_b64_tr_b16 v[206:207], v14 offset:10752
    s_waitcnt vmcnt(10)
    ds_write_b128 v12, v[208:211] offset:12288
    ds_write_b128 v12, v[212:215] offset:13312
    s_waitcnt lgkmcnt(2)
    global_store_dwordx4 v15, v[200:203], s[8:9] sc1
    global_store_dwordx4 v15, v[204:207], s[8:9] offset:1024 sc1
    v_add_u32 v15, 8192, v15
    s_waitcnt lgkmcnt(0)
    ds_read_b64_tr_b16 v[208:209], v13 offset:12288
    ds_read_b64_tr_b16 v[210:211], v13 offset:12800
    ds_read_b64_tr_b16 v[212:213], v14 offset:12288
    ds_read_b64_tr_b16 v[214:215], v14 offset:12800
    s_waitcnt lgkmcnt(0)
    global_store_dwordx4 v15, v[208:211], s[8:9] sc1
    global_store_dwordx4 v15, v[212:215], s[8:9] offset:1024 sc1
    global_load_dword v151, v153, s[76:77] sc1
    v_lshrrev_b32 v6, 3, v3
    v_and_b32 v7, 7, v0
    s_lshl_b32 s7, s6, 4
    v_add_u32 v6, s7, v6
    v_lshlrev_b32 v7, 4, v7
    s_movk_i32 s16, 896
    v_mad_u32_u24 v8, v6, s16, v7
    s_mul_i32 s17, s34, 57344
    v_add_u32 v8, s17, v8
    v_add_u32 v9, 7168, v8
    global_load_dwordx4 v[16:19], v8, s[26:27]
    global_load_dwordx4 v[20:23], v9, s[26:27]
    v_add_u32 v8, 128, v8
    v_add_u32 v9, 128, v9
    global_load_dwordx4 v[24:27], v8, s[26:27]
    global_load_dwordx4 v[28:31], v9, s[26:27]
    v_add_u32 v8, 128, v8
    v_add_u32 v9, 128, v9
    global_load_dwordx4 v[32:35], v8, s[26:27]
    global_load_dwordx4 v[36:39], v9, s[26:27]
    v_add_u32 v8, 128, v8
    v_add_u32 v9, 128, v9
    global_load_dwordx4 v[40:43], v8, s[26:27]
    global_load_dwordx4 v[44:47], v9, s[26:27]
    v_add_u32 v8, 128, v8
    v_add_u32 v9, 128, v9
    global_load_dwordx4 v[48:51], v8, s[26:27]
    global_load_dwordx4 v[52:55], v9, s[26:27]
    v_add_u32 v8, 128, v8
    v_add_u32 v9, 128, v9
    global_load_dwordx4 v[56:59], v8, s[26:27]
    global_load_dwordx4 v[60:63], v9, s[26:27]
    v_add_u32 v8, 128, v8
    v_add_u32 v9, 128, v9
    global_load_dwordx4 v[64:67], v8, s[26:27]
    global_load_dwordx4 v[68:71], v9, s[26:27]
    s_waitcnt vmcnt(14)
    v_readfirstlane_b32 s33, v151
    s_mov_b32 s35, 0
F_n2_l:
    s_cmp_lg_u32 s33, 0
    s_cbranch_scc1 F_n2_ok
    global_load_dword v151, v153, s[76:77] sc1
    s_add_u32 s35, s35, 1
    s_waitcnt vmcnt(0)
    v_readfirstlane_b32 s33, v151
    s_cmp_lt_u32 s35, 0x80000
    s_cbranch_scc1 F_n2_l
F_n2_ok:
    s_barrier
    s_cmp_lg_u32 s6, 0
    s_cbranch_scc1 F_sf1
    s_lshl_b32 s3, s34, 6
    s_add_u32 s3, s3, 2392064
    v_mov_b32 v150, s3
    s_mov_b64 exec, 1
    global_store_dword v150, v151, s[8:9] sc1
    s_mov_b64 exec, -1
F_sf1:
    s_mul_i32 s7, s6, 14336
    v_bfe_u32 v10, v0, 4, 1
    v_lshlrev_b32 v11, 6, v10
    v_xor_b32 v12, v1, v11
    v_add_u32 v12, s7, v12
    v_bfe_u32 v6, v0, 5, 1
    v_bfe_u32 v13, v0, 2, 2
    v_lshlrev_b32 v13, 7, v13
    v_lshl_add_u32 v13, v10, 5, v13
    v_and_b32 v10, 3, v0
    v_lshl_add_u32 v13, v10, 3, v13
    v_bfe_u32 v10, v0, 3, 1
    v_lshlrev_b32 v10, 6, v10
    v_xor_b32 v13, v13, v10
    v_add_u32 v13, s7, v13
    v_lshl_add_u32 v13, v6, 9, v13
    v_xor_b32 v14, 64, v13
    s_and_b32 s17, s34, 3
    s_mul_i32 s17, s17, 28
    s_and_b32 s7, s34, -4
    s_add_u32 s17, s17, s7
    s_lshl_b32 s17, s17, 11
    s_add_u32 s17, s17, 5242880
    s_lshl_b32 s7, s6, 11
    s_add_u32 s17, s17, s7
    v_add_u32 v15, s17, v1
    s_waitcnt vmcnt(12)
    ds_write_b128 v12, v[16:19] offset:0
    ds_write_b128 v12, v[20:23] offset:1024
    s_waitcnt lgkmcnt(0)
    ds_read_b64_tr_b16 v[16:17], v13 offset:0
    ds_read_b64_tr_b16 v[18:19], v13 offset:1024
    ds_read_b64_tr_b16 v[20:21], v14 offset:0
    ds_read_b64_tr_b16 v[22:23], v14 offset:1024
    s_waitcnt vmcnt(10)
    ds_write_b128 v12, v[24:27] offset:2048
    ds_write_b128 v12, v[28:31] offset:3072
    s_waitcnt lgkmcnt(2)
    global_store_dwordx4 v15, v[16:19], s[8:9] sc1
    global_store_dwordx4 v15, v[20:23], s[8:9] offset:1024 sc1
    v_add_u32 v15, 229376, v15
    s_waitcnt lgkmcnt(0)
    ds_read_b64_tr_b16 v[24:25], v13 offset:2048
    ds_read_b64_tr_b16 v[26:27], v13 offset:3072
    ds_read_b64_tr_b16 v[28:29], v14 offset:2048
    ds_read_b64_tr_b16 v[30:31], v14 offset:3072
    s_waitcnt vmcnt(10)
    ds_write_b128 v12, v[32:35] offset:4096
    ds_write_b128 v12, v[36:39] offset:5120
    s_waitcnt lgkmcnt(2)
    global_store_dwordx4 v15, v[24:27], s[8:9] sc1
    global_store_dwordx4 v15, v[28:31], s[8:9] offset:1024 sc1
    v_add_u32 v15, 229376, v15
    s_waitcnt lgkmcnt(0)
    ds_read_b64_tr_b16 v[32:33], v13 offset:4096
    ds_read_b64_tr_b16 v[34:35], v13 offset:5120
    ds_read_b64_tr_b16 v[36:37], v14 offset:4096
    ds_read_b64_tr_b16 v[38:39], v14 offset:5120
    s_waitcnt vmcnt(10)
    ds_write_b128 v12, v[40:43] offset:6144
    ds_write_b128 v12, v[44:47] offset:7168
    s_waitcnt lgkmcnt(2)
    global_store_dwordx4 v15, v[32:35], s[8:9] sc1
    global_store_dwordx4 v15, v[36:39], s[8:9] offset:1024 sc1
    v_add_u32 v15, 229376, v15
    s_waitcnt lgkmcnt(0)
    ds_read_b64_tr_b16 v[40:41], v13 offset:6144
    ds_read_b64_tr_b16 v[42:43], v13 offset:7168
    ds_read_b64_tr_b16 v[44:45], v14 offset:6144
    ds_read_b64_tr_b16 v[46:47], v14 offset:7168
    s_waitcnt vmcnt(10)
    ds_write_b128 v12, v[48:51] offset:8192
    ds_write_b128 v12, v[52:55] offset:9216
    s_waitcnt lgkmcnt(2)
    global_store_dwordx4 v15, v[40:43], s[8:9] sc1
    global_store_dwordx4 v15, v[44:47], s[8:9] offset:1024 sc1
    v_add_u32 v15, 229376, v15
    s_waitcnt lgkmcnt(0)
    ds_read_b64_tr_b16 v[48:49], v13 offset:8192
    ds_read_b64_tr_b16 v[50:51], v13 offset:9216
    ds_read_b64_tr_b16 v[52:53], v14 offset:8192
    ds_read_b64_tr_b16 v[54:55], v14 offset:9216
    s_waitcnt vmcnt(10)
    ds_write_b128 v12, v[56:59] offset:10240
    ds_write_b128 v12, v[60:63] offset:11264
    s_waitcnt lgkmcnt(2)
    global_store_dwordx4 v15, v[48:51], s[8:9] sc1
    global_store_dwordx4 v15, v[52:55], s[8:9] offset:1024 sc1
    v_add_u32 v15, 229376, v15
    s_waitcnt lgkmcnt(0)
    ds_read_b64_tr_b16 v[56:57], v13 offset:10240
    ds_read_b64_tr_b16 v[58:59], v13 offset:11264
    ds_read_b64_tr_b16 v[60:61], v14 offset:10240
    ds_read_b64_tr_b16 v[62:63], v14 offset:11264
    s_waitcnt vmcnt(10)
    ds_write_b128 v12, v[64:67] offset:12288
    ds_write_b128 v12, v[68:71] offset:13312
    s_waitcnt lgkmcnt(2)
    global_store_dwordx4 v15, v[56:59], s[8:9] sc1
    global_store_dwordx4 v15, v[60:63], s[8:9] offset:1024 sc1
    v_add_u32 v15, 229376, v15
    s_waitcnt lgkmcnt(0)
    ds_read_b64_tr_b16 v[64:65], v13 offset:12288
    ds_read_b64_tr_b16 v[66:67], v13 offset:13312
    ds_read_b64_tr_b16 v[68:69], v14 offset:12288
    ds_read_b64_tr_b16 v[70:71], v14 offset:13312
    s_waitcnt lgkmcnt(0)
    global_store_dwordx4 v15, v[64:67], s[8:9] sc1
    global_store_dwordx4 v15, v[68:71], s[8:9] offset:1024 sc1
    s_lshl_b32 s7, s34, 6
    s_add_u32 s7, s7, 2688
    global_load_ushort v120, v152, s[64:65] offset:0
    global_load_ushort v121, v152, s[64:65] offset:128
    global_load_ushort v122, v152, s[64:65] offset:256
    global_load_ushort v123, v152, s[64:65] offset:384
    global_load_ushort v124, v152, s[64:65] offset:512
    global_load_ushort v125, v152, s[64:65] offset:640
    global_load_ushort v126, v152, s[64:65] offset:768
    buffer_load_dwordx4 v[92:95], v154, s[72:75], s7 offen
    s_add_u32 s7, s7, 344064
    buffer_load_dwordx4 v[96:99], v154, s[72:75], s7 offen
    s_add_u32 s7, s7, 344064
    buffer_load_dwordx4 v[100:103], v154, s[72:75], s7 offen
    s_add_u32 s7, s7, 344064
    buffer_load_dwordx4 v[104:107], v154, s[72:75], s7 offen
    s_add_u32 s7, s7, 344064
    buffer_load_dwordx4 v[108:111], v154, s[72:75], s7 offen
    s_add_u32 s7, s7, 344064
    buffer_load_dwordx4 v[112:115], v154, s[72:75], s7 offen
    s_add_u32 s7, s7, 344064
    buffer_load_dwordx4 v[116:119], v154, s[72:75], s7 offen
    s_waitcnt vmcnt(14)
    s_barrier
    s_cmp_lg_u32 s6, 0
    s_cbranch_scc1 F_sf2
    s_lshl_b32 s3, s34, 6
    s_add_u32 s3, s3, 2394112
    v_mov_b32 v150, s3
    s_mov_b64 exec, 1
    global_store_dword v150, v151, s[8:9] sc1
    s_mov_b64 exec, -1
F_sf2:
    s_waitcnt vmcnt(0)
    s_branch F_sp_red
F_sp_modonly:
    v_readfirstlane_b32 s33, v151
    s_mov_b32 s35, 0
F_n3_l:
    s_cmp_lg_u32 s33, 0
    s_cbranch_scc1 F_n3_ok
    global_load_dword v151, v153, s[76:77] sc1
    s_add_u32 s35, s35, 1
    s_waitcnt vmcnt(0)
    v_readfirstlane_b32 s33, v151
    s_cmp_lt_u32 s35, 0x80000
    s_cbranch_scc1 F_n3_l
F_n3_ok:
F_sp_loop:
    s_lshl_b32 s7, s34, 6
    s_add_u32 s7, s7, 2688
    global_load_ushort v120, v152, s[64:65] offset:0
    global_load_ushort v121, v152, s[64:65] offset:128
    global_load_ushort v122, v152, s[64:65] offset:256
    global_load_ushort v123, v152, s[64:65] offset:384
    global_load_ushort v124, v152, s[64:65] offset:512
    global_load_ushort v125, v152, s[64:65] offset:640
    global_load_ushort v126, v152, s[64:65] offset:768
    buffer_load_dwordx4 v[92:95], v154, s[72:75], s7 offen
    s_add_u32 s7, s7, 344064
    buffer_load_dwordx4 v[96:99], v154, s[72:75], s7 offen
    s_add_u32 s7, s7, 344064
    buffer_load_dwordx4 v[100:103], v154, s[72:75], s7 offen
    s_add_u32 s7, s7, 344064
    buffer_load_dwordx4 v[104:107], v154, s[72:75], s7 offen
    s_add_u32 s7, s7, 344064
    buffer_load_dwordx4 v[108:111], v154, s[72:75], s7 offen
    s_add_u32 s7, s7, 344064
    buffer_load_dwordx4 v[112:115], v154, s[72:75], s7 offen
    s_add_u32 s7, s7, 344064
    buffer_load_dwordx4 v[116:119], v154, s[72:75], s7 offen
F_sp_red:
    v_mov_b32 v140, 0
    v_mov_b32 v141, 0
    v_mov_b32 v142, 0
    v_mov_b32 v143, 0
    v_mov_b32 v144, 0
    v_mov_b32 v145, 0
    v_mov_b32 v146, 0
    v_mov_b32 v147, 0
    s_lshl_b32 s16, s6, 7
    s_add_u32 s16, s16, 111616
    v_lshl_add_u32 v156, v5, 5, s16
    v_bfe_u32 v157, v0, 4, 1
    v_lshl_add_u32 v156, v157, 3, v156
    v_bfe_u32 v157, v0, 5, 1
    v_lshl_add_u32 v156, v157, 2, v156
    s_mov_b32 s16, 3216550459
    s_waitcnt vmcnt(7)
    v_lshlrev_b32 v120, 16, v120
    v_lshlrev_b32 v121, 16, v121
    v_lshlrev_b32 v122, 16, v122
    v_lshlrev_b32 v123, 16, v123
    v_lshlrev_b32 v124, 16, v124
    v_lshlrev_b32 v125, 16, v125
    v_lshlrev_b32 v126, 16, v126
    v_mul_f32 v128, s16, v120
    v_mul_f32 v129, s16, v121
    v_mul_f32 v130, s16, v122
    v_mul_f32 v131, s16, v123
    v_mul_f32 v132, s16, v124
    v_mul_f32 v133, s16, v125
    v_mul_f32 v134, s16, v126
    v_exp_f32 v128, v128
    v_exp_f32 v129, v129
    v_exp_f32 v130, v130
    v_exp_f32 v131, v131
    v_exp_f32 v132, v132
    v_exp_f32 v133, v133
    v_exp_f32 v134, v134
    v_add_f32 v128, 1.0, v128
    v_add_f32 v129, 1.0, v129
    v_add_f32 v130, 1.0, v130
    v_add_f32 v131, 1.0, v131
    v_add_f32 v132, 1.0, v132
    v_add_f32 v133, 1.0, v133
    v_add_f32 v134, 1.0, v134
    v_rcp_f32 v128, v128
    v_rcp_f32 v129, v129
    v_rcp_f32 v130, v130
    v_rcp_f32 v131, v131
    v_rcp_f32 v132, v132
    v_rcp_f32 v133, v133
    v_rcp_f32 v134, v134
    v_mul_f32 v120, v120, v128
    v_mul_f32 v121, v121, v129
    v_mul_f32 v122, v122, v130
    v_mul_f32 v123, v123, v131
    v_mul_f32 v124, v124, v132
    v_mul_f32 v125, v125, v133
    v_mul_f32 v126, v126, v134
    v_cvt_pk_bf16_f32 v120, v120, 0
    v_cvt_pk_bf16_f32 v121, v121, 0
    v_cvt_pk_bf16_f32 v122, v122, 0
    v_cvt_pk_bf16_f32 v123, v123, 0
    v_cvt_pk_bf16_f32 v124, v124, 0
    v_cvt_pk_bf16_f32 v125, v125, 0
    v_cvt_pk_bf16_f32 v126, v126, 0
    v_lshlrev_b32 v128, 16, v120
    v_lshlrev_b32 v129, 16, v121
    v_lshlrev_b32 v130, 16, v122
    v_lshlrev_b32 v131, 16, v123
    v_lshlrev_b32 v132, 16, v124
    v_lshlrev_b32 v133, 16, v125
    v_lshlrev_b32 v134, 16, v126
    s_waitcnt vmcnt(6)
    v_dot2c_f32_bf16 v140, v92, v120
    v_dot2c_f32_bf16 v141, v92, v128
    v_dot2c_f32_bf16 v142, v93, v120
    v_dot2c_f32_bf16 v143, v93, v128
    v_dot2c_f32_bf16 v144, v94, v120
    v_dot2c_f32_bf16 v145, v94, v128
    v_dot2c_f32_bf16 v146, v95, v120
    v_dot2c_f32_bf16 v147, v95, v128
    s_waitcnt vmcnt(5)
    v_dot2c_f32_bf16 v140, v96, v121
    v_dot2c_f32_bf16 v141, v96, v129
    v_dot2c_f32_bf16 v142, v97, v121
    v_dot2c_f32_bf16 v143, v97, v129
    v_dot2c_f32_bf16 v144, v98, v121
    v_dot2c_f32_bf16 v145, v98, v129
    v_dot2c_f32_bf16 v146, v99, v121
    v_dot2c_f32_bf16 v147, v99, v129
    s_waitcnt vmcnt(4)
    v_dot2c_f32_bf16 v140, v100, v122
    v_dot2c_f32_bf16 v141, v100, v130
    v_dot2c_f32_bf16 v142, v101, v122
    v_dot2c_f32_bf16 v143, v101, v130
    v_dot2c_f32_bf16 v144, v102, v122
    v_dot2c_f32_bf16 v145, v102, v130
    v_dot2c_f32_bf16 v146, v103, v122
    v_dot2c_f32_bf16 v147, v103, v130
    s_waitcnt vmcnt(3)
    v_dot2c_f32_bf16 v140, v104, v123
    v_dot2c_f32_bf16 v141, v104, v131
    v_dot2c_f32_bf16 v142, v105, v123
    v_dot2c_f32_bf16 v143, v105, v131
    v_dot2c_f32_bf16 v144, v106, v123
    v_dot2c_f32_bf16 v145, v106, v131
    v_dot2c_f32_bf16 v146, v107, v123
    v_dot2c_f32_bf16 v147, v107, v131
    s_waitcnt vmcnt(2)
    v_dot2c_f32_bf16 v140, v108, v124
    v_dot2c_f32_bf16 v141, v108, v132
    v_dot2c_f32_bf16 v142, v109, v124
    v_dot2c_f32_bf16 v143, v109, v132
    v_dot2c_f32_bf16 v144, v110, v124
    v_dot2c_f32_bf16 v145, v110, v132
    v_dot2c_f32_bf16 v146, v111, v124
    v_dot2c_f32_bf16 v147, v111, v132
    s_waitcnt vmcnt(1)
    v_dot2c_f32_bf16 v140, v112, v125
    v_dot2c_f32_bf16 v141, v112, v133
    v_dot2c_f32_bf16 v142, v113, v125
    v_dot2c_f32_bf16 v143, v113, v133
    v_dot2c_f32_bf16 v144, v114, v125
    v_dot2c_f32_bf16 v145, v114, v133
    v_dot2c_f32_bf16 v146, v115, v125
    v_dot2c_f32_bf16 v147, v115, v133
    s_waitcnt vmcnt(0)
    v_dot2c_f32_bf16 v140, v116, v126
    v_dot2c_f32_bf16 v141, v116, v134
    v_dot2c_f32_bf16 v142, v117, v126
    v_dot2c_f32_bf16 v143, v117, v134
    v_dot2c_f32_bf16 v144, v118, v126
    v_dot2c_f32_bf16 v145, v118, v134
    v_dot2c_f32_bf16 v146, v119, v126
    v_dot2c_f32_bf16 v147, v119, v134
    v_permlane32_swap_b32 v140, v141
    v_permlane32_swap_b32 v142, v143
    v_permlane32_swap_b32 v144, v145
    v_permlane32_swap_b32 v146, v147
    v_add_f32 v140, v140, v141
    v_add_f32 v142, v142, v143
    v_add_f32 v144, v144, v145
    v_add_f32 v146, v146, v147
    v_permlane16_swap_b32 v140, v142
    s_nop 0
    v_permlane16_swap_b32 v144, v146
    v_add_f32 v140, v140, v142
    v_add_f32 v144, v144, v146
    s_nop 0
    v_add_f32_dpp v140, v140, v140 row_ror:8 row_mask:0xf bank_mask:0xf
    v_add_f32_dpp v144, v144, v144 row_ror:8 row_mask:0xf bank_mask:0xf
    s_nop 0
    v_add_f32_dpp v140, v140, v140 row_ror:4 row_mask:0xf bank_mask:0xf
    v_add_f32_dpp v144, v144, v144 row_ror:4 row_mask:0xf bank_mask:0xf
    ds_write_b32 v156, v140
    ds_write_b32 v156, v144 offset:16
    s_waitcnt lgkmcnt(0)
    s_barrier
    s_cmp_lg_u32 s6, 0
    s_cbranch_scc1 F_sp_next
    s_mov_b32 exec_hi, 0
    v_lshlrev_b32 v156, 2, v0
    v_add_u32 v157, 111616, v156
    ds_read2_b32 v[112:113], v157 offset0:0 offset1:32
    ds_read2_b32 v[114:115], v157 offset0:64 offset1:96
    s_lshl_b32 s17, s34, 7
    s_add_u32 s17, s17, 2168064
    v_add_u32 v158, s17, v156
    s_waitcnt lgkmcnt(0)
    v_add_f32 v112, v112, v113
    v_add_f32 v114, v114, v115
    v_add_f32 v112, v112, v114
    v_cvt_pk_bf16_f32 v120, 0, v112
    global_store_dword v158, v120, s[8:9] sc1
    s_cmp_ge_u32 s34, 28
    s_cbranch_scc1 F_sp_st
    s_lshl_b32 s17, s34, 3
    s_add_u32 s17, s17, 2195460
    s_cmp_ge_u32 s34, 14
    s_cbranch_scc0 F_mod_cs
    s_sub_u32 s17, s17, 116
    v_add_f32 v120, 1.0, v120
    v_cvt_pk_bf16_f32 v120, 0, v120
F_mod_cs:
    v_mul_f32 v120, 1069066811, v120
    v_mul_u32_u24 v158, 112, v0
    v_add_u32 v158, s17, v158
    global_store_dword v158, v120, s[8:9] sc1
F_sp_st:
    s_mov_b64 exec, -1
F_sp_next:
    s_waitcnt vmcnt(0)
    s_barrier
    s_cmp_lt_u32 s34, 28
    s_cselect_b32 s34, 64, s34
    s_add_u32 s34, s34, 4
    s_cmp_lt_u32 s34, 42
    s_cbranch_scc1 F_sp_loop
    s_sub_u32 s34, s2, 224
    s_barrier
    s_cmp_lg_u32 s6, 0
    s_cbranch_scc1 F_sf3
    s_lshl_b32 s3, s34, 6
    s_add_u32 s3, s3, 2340864
    v_mov_b32 v150, s3
    s_mov_b64 exec, 1
    global_store_dword v150, v151, s[8:9] sc1
    s_mov_b64 exec, -1
F_sf3:
    s_endpgm
code_end:
.section .rodata,"a"
.p2align 6
.amdhsa_kernel adaLN_cond__ssm_conv_s4__dense_activation_silu__prompt_kernel
  .amdhsa_next_free_vgpr 512
  .amdhsa_next_free_sgpr 80
  .amdhsa_accum_offset 256
  .amdhsa_group_segment_fixed_size 0
  .amdhsa_kernarg_size 136
  .amdhsa_user_sgpr_count 2
  .amdhsa_user_sgpr_kernarg_segment_ptr 1
  .amdhsa_system_sgpr_workgroup_id_x 1
.end_amdhsa_kernel
```
